```python
import torch

def _softmax(x, axis=-1):
    return torch.softmax(x, dim=axis)
def _gelu(x):
    return torch.nn.functional.gelu(x, approximate="tanh")
def _silu(x):
    return torch.nn.functional.silu(x)
def _sigmoid(x):
    return torch.sigmoid(x)
def _layernorm(x, axis=-1, eps=1e-5):
    m = x.mean(dim=axis, keepdim=True)
    v = x.var(dim=axis, keepdim=True, unbiased=False)
    return (x - m) / torch.sqrt(v + eps)
def _scatter_add(tgt, idx, src, axis=0):
    return tgt.clone().index_add_(axis, idx, src)
def _segment_sum(src, seg, n):
    out = torch.zeros((n,) + src.shape[1:], dtype=src.dtype)
    return out.index_add_(0, seg, src)
def _pad(x, pw):
    flat = tuple(v for pair in reversed(pw) for v in pair)
    return torch.nn.functional.pad(x, flat)

kernel_name = 'concat_heads__gqa_block_cached__sliding_block_cached__decode'

def setup_inputs():

    _w = (lambda a: (lambda t: t.to(torch.bfloat16) if t.is_floating_point() else t)(torch.as_tensor(a)))
    def _A_setup():
        B, Sq, D = 1, 1, 1024
        Hq, Hkv, Sk, Dh = 32, 4, 65536, 128
        assert Hq % Hkv == 0, (Hq, Hkv)
        return {
            "x": _w((lambda *s: torch.randn(*s, dtype=torch.bfloat16) * 0.4)(B, Sq, D)),
            "k_cache": _w((lambda *s: torch.randn(*s, dtype=torch.bfloat16) * 3.2)(B, Hkv, Sk, Dh)),
            "v_cache": _w((lambda *s: torch.randn(*s, dtype=torch.bfloat16) * 0.8)(B, Hkv, Sk, Dh)),
            "wq": _w((lambda *s: torch.randn(*s, dtype=torch.bfloat16) * 3.2)(D, Hq * Dh) * (D ** -0.5)),
            "wo": _w((lambda *s: torch.randn(*s, dtype=torch.bfloat16) * 0.8)(Hq * Dh, D) * ((Hq * Dh) ** -0.5)),
        }
    _A_in = _A_setup()

    def _B_setup():
        B, Sq, D = 1, 1, 1024
        Hq, Hkv, Sk, Dh = 32, 4, 65536, 128
        assert Hq % Hkv == 0, (Hq, Hkv)
        return {
            "x": _w((lambda *s: torch.randn(*s, dtype=torch.bfloat16) * 0.2)(B, Sq, D)),
            "k_cache": _w((lambda *s: torch.randn(*s, dtype=torch.bfloat16) * 3.2)(B, Hkv, Sk, Dh)),
            "v_cache": _w((lambda *s: torch.randn(*s, dtype=torch.bfloat16) * 1.6)(B, Hkv, Sk, Dh)),
            "wq": _w((lambda *s: torch.randn(*s, dtype=torch.bfloat16) * 3.2)(D, Hq * Dh) * (D ** -0.5)),
            "wo": _w((lambda *s: torch.randn(*s, dtype=torch.bfloat16) * 1.6)(Hq * Dh, D) * ((Hq * Dh) ** -0.5)),
        }
    _B_in = _B_setup()

    return {
        "A_x": _A_in["x"],
        "A_k_cache": _A_in["k_cache"],
        "A_v_cache": _A_in["v_cache"],
        "A_wq": _A_in["wq"],
        "A_wo": _A_in["wo"],
        "B_x": _B_in["x"],
        "B_k_cache": _B_in["k_cache"],
        "B_v_cache": _B_in["v_cache"],
        "B_wq": _B_in["wq"],
        "B_wo": _B_in["wo"],
    }

def reference(A_x, A_k_cache, A_v_cache, A_wq, A_wo, B_x, B_k_cache, B_v_cache, B_wq, B_wo):
    def _A_ref(x, k_cache, v_cache, wq, wo):
        B, Sq, D = x.shape
        Hq, Dh = 32, 128
        Hkv = k_cache.shape[1]
        rep = Hq // Hkv
        q = (lambda x, *d: x.permute(*d))((x @ wq).reshape(B, Sq, Hq, Dh), 0, 2, 1, 3)
        k = (lambda x, n, axis: torch.repeat_interleave(x, n, dim=axis))(k_cache, rep, axis=1)
        v = (lambda x, n, axis: torch.repeat_interleave(x, n, dim=axis))(v_cache, rep, axis=1)
        scores = torch.einsum("bhqd,bhkd->bhqk", q, k) * (Dh ** -0.5)
        p = _softmax(scores, axis=-1)
        o = torch.einsum("bhqk,bhkd->bhqd", p, v)
        return (lambda x, *d: x.permute(*d))(o, 0, 2, 1, 3).reshape(B, Sq, Hq * Dh) @ wo

    def _B_ref(x, k_cache, v_cache, wq, wo):
        B, Sq, D = x.shape
        Hq, Dh = 32, 128
        Hkv, Sk = k_cache.shape[1], k_cache.shape[2]
        W = min(4096, max(256, Sk // 4))
        rep = Hq // Hkv
        q = (lambda x, *d: x.permute(*d))((x @ wq).reshape(B, Sq, Hq, Dh), 0, 2, 1, 3)
        k = (lambda x, n, axis: torch.repeat_interleave(x, n, dim=axis))(k_cache[:, :, Sk - W:, :], rep, axis=1)
        v = (lambda x, n, axis: torch.repeat_interleave(x, n, dim=axis))(v_cache[:, :, Sk - W:, :], rep, axis=1)
        scores = torch.einsum("bhqd,bhkd->bhqk", q, k) * (Dh ** -0.5)
        p = _softmax(scores, axis=-1)
        o = torch.einsum("bhqk,bhkd->bhqd", p, v)
        return (lambda x, *d: x.permute(*d))(o, 0, 2, 1, 3).reshape(B, Sq, Hq * Dh) @ wo

    a = _A_ref(A_x, A_k_cache, A_v_cache, A_wq, A_wo)
    b = _B_ref(B_x, B_k_cache, B_v_cache, B_wq, B_wo)
    return torch.concatenate([a, b], axis=-1)
```

```asm
; @launch grid=(256,1,1) block=(512,1,1) lds=153344
.amdgcn_target "amdgcn-amd-amdhsa--gfx950"
.text
.globl concat_heads__gqa_block_cached__sliding_block_cached__decode_kernel
.p2align 8
.type concat_heads__gqa_block_cached__sliding_block_cached__decode_kernel,@function
concat_heads__gqa_block_cached__sliding_block_cached__decode_kernel:
  s_cmp_ge_u32 s2, 256
  s_cbranch_scc1 L_END
  s_load_dwordx16 s[16:31], s[0:1], 0
  s_load_dwordx8 s[32:39], s[0:1], 64
  s_load_dwordx2 s[40:41], s[0:1], 96
  v_lshrrev_b32 v2, 6, v0
  v_and_b32 v1, 63, v0
  v_readfirstlane_b32 s3, v2
  s_lshr_b32 s6, s2, 6
  s_bfe_u32 s86, s2, 0x30003
  s_and_b32 s87, s2, 7
  s_xor_b32 s42, s86, s87
  s_cmp_ge_u32 s3, 4
  s_cbranch_scc1 L_S
  s_and_b32 s43, s6, 1
  s_xor_b32 s9, s87, s43
  s_lshl_b32 s9, s9, 3
  s_or_b32 s9, s9, s42
  v_lshrrev_b32 v3, 3, v1
  v_and_b32 v4, 7, v1
  v_lshlrev_b32 v5, 14, v3
  v_lshl_add_u32 v5, v4, 4, v5
  v_lshlrev_b32 v6, 2, v3
  s_lshl_b32 s11, s43, 2
  s_add_u32 s11, s11, s3
  s_lshl_b32 s10, s11, 17
  s_lshl_b32 s12, s9, 7
  s_add_u32 s10, s10, s12
  s_lshl_b32 s11, s11, 5
  s_mov_b32 s46, 8388608
  s_mov_b32 s47, 0x00020000
  s_mov_b32 s50, 2048
  s_mov_b32 s51, 0x00020000
  s_cmp_lt_u32 s2, 128
  s_waitcnt lgkmcnt(0)
  s_cselect_b32 s44, s22, s32
  s_cselect_b32 s45, s23, s33
  s_cselect_b32 s48, s16, s26
  s_cselect_b32 s49, s17, s27
  buffer_load_dwordx4 v[64:67], v5, s[44:47], s10 offen nt
  s_add_u32 s10, s10, 8192
  buffer_load_dwordx4 v[68:71], v5, s[44:47], s10 offen nt
  s_add_u32 s10, s10, 1040384
  buffer_load_dwordx4 v[72:75], v5, s[44:47], s10 offen nt
  s_add_u32 s10, s10, 8192
  buffer_load_dwordx4 v[76:79], v5, s[44:47], s10 offen nt
  s_add_u32 s10, s10, 1040384
  buffer_load_dwordx4 v[80:83], v5, s[44:47], s10 offen nt
  s_add_u32 s10, s10, 8192
  buffer_load_dwordx4 v[84:87], v5, s[44:47], s10 offen nt
  s_add_u32 s10, s10, 1040384
  buffer_load_dwordx4 v[88:91], v5, s[44:47], s10 offen nt
  s_add_u32 s10, s10, 8192
  buffer_load_dwordx4 v[92:95], v5, s[44:47], s10 offen nt
  buffer_load_dword v16, v6, s[48:51], s11 offen offset:0
  buffer_load_dword v17, v6, s[48:51], s11 offen offset:256
  buffer_load_dword v18, v6, s[48:51], s11 offen offset:512
  buffer_load_dword v19, v6, s[48:51], s11 offen offset:768
  buffer_load_dword v20, v6, s[48:51], s11 offen offset:1024
  buffer_load_dword v21, v6, s[48:51], s11 offen offset:1280
  buffer_load_dword v22, v6, s[48:51], s11 offen offset:1536
  buffer_load_dword v23, v6, s[48:51], s11 offen offset:1792
  s_add_u32 s10, s10, 1040384
  buffer_load_dwordx4 v[96:99], v5, s[44:47], s10 offen nt
  s_add_u32 s10, s10, 8192
  buffer_load_dwordx4 v[100:103], v5, s[44:47], s10 offen nt
  s_add_u32 s10, s10, 1040384
  buffer_load_dwordx4 v[104:107], v5, s[44:47], s10 offen nt
  s_add_u32 s10, s10, 8192
  buffer_load_dwordx4 v[108:111], v5, s[44:47], s10 offen nt
  s_add_u32 s10, s10, 1040384
  buffer_load_dwordx4 v[112:115], v5, s[44:47], s10 offen nt
  s_add_u32 s10, s10, 8192
  buffer_load_dwordx4 v[116:119], v5, s[44:47], s10 offen nt
  s_add_u32 s10, s10, 1040384
  buffer_load_dwordx4 v[120:123], v5, s[44:47], s10 offen nt
  s_add_u32 s10, s10, 8192
  buffer_load_dwordx4 v[124:127], v5, s[44:47], s10 offen nt
  s_load_dword s91, s[40:41], 0
  v_mov_b32 v7, 0
  s_mov_b32 s4, 0x05040100
  s_mov_b32 s5, 0x07060302
  s_and_b32 s7, s2, 63
  s_and_b32 s88, s42, 3
  s_cmp_eq_u32 s88, 0
  s_cselect_b32 s88, 1, 0
  s_lshr_b32 s42, s42, 2
  s_mov_b32 s52, s40
  s_mov_b32 s53, s41
  s_mov_b32 s54, 2097152
  s_mov_b32 s55, 0x00020000
  s_mov_b32 s60, s36
  s_mov_b32 s61, s37
  s_mov_b32 s62, 4096
  s_mov_b32 s63, 0x00020000
  s_mov_b32 s64, s38
  s_mov_b32 s65, s39
  s_mov_b32 s66, 256
  s_mov_b32 s67, 0x00020000
  s_mov_b32 s56, s24
  s_mov_b32 s57, s25
  s_mov_b32 s58, 8388608
  s_mov_b32 s59, 0x00020000
  s_and_b32 s10, s2, 0xc1
  s_or_b32 s10, s10, s3
  s_cmp_lg_u32 s10, 0
  s_cselect_b32 s54, 0, s54
  s_lshl_b32 s10, s87, 2
  s_add_u32 s10, s10, s86
  s_lshl_b32 s10, s10, 8
  s_add_u32 s10, s10, 4096
  v_mov_b32 v15, 352
  s_mov_b64 exec, 1
  buffer_store_dword v15, v7, s[52:55], s10 offen sc1
  s_mov_b64 exec, -1
  s_mov_b32 s54, 2097152
  v_mov_b32 v24, 0
  v_mov_b32 v25, 0
  v_mov_b32 v26, 0
  v_mov_b32 v27, 0
  v_mov_b32 v28, 0
  v_mov_b32 v29, 0
  v_mov_b32 v30, 0
  v_mov_b32 v31, 0
  v_lshrrev_b32 v2, 4, v1
  s_lshl_b32 s10, s3, 2
  v_add_u32 v60, s10, v2
  v_lshlrev_b32 v60, 8, v60
  v_lshl_add_u32 v60, v4, 5, v60
  s_mov_b32 s13, 4294966272
  s_mov_b32 s14, 0xffffff00
  s_mov_b32 s28, 0xff
  v_lshlrev_b32 v12, 4, v1
  v_and_b32 v3, 15, v1
  v_lshlrev_b32 v14, 10, v2
  v_lshl_add_u32 v14, v3, 4, v14
  s_lshl_b32 s29, s6, 14
  s_lshl_b32 s11, s9, 8
  s_add_u32 s29, s29, s11
  s_add_u32 s29, s29, 65536
  s_lshl_b32 s32, s6, 12
  s_lshl_b32 s11, s3, 10
  s_add_u32 s32, s32, s11
  s_add_u32 s32, s32, 65536
  s_add_u32 s33, s32, 16384
  s_add_u32 s90, s32, 32768
  s_add_u32 s68, s32, 49152
  s_lshl_b32 s10, s3, 9
  v_lshl_add_u32 v13, v1, 3, s10
  s_mov_b64 s[16:17], -1
  s_mov_b64 s[18:19], -1
  s_cmp_eq_u32 s88, 1
  s_cselect_b64 s[20:21], -1, 0
  s_cselect_b64 s[22:23], -1, 0
  s_waitcnt lgkmcnt(0)
  s_add_u32 s91, s91, 0x101
  v_mov_b32 v8, s91
  v_add_u32 v9, 2869, v8
  v_add_u32 v10, 9617, v8
  v_add_u32 v11, 1383, v8
  v_and_b32 v136, s28, v8
  v_and_b32 v137, s28, v9
  v_and_b32 v138, s28, v10
  v_and_b32 v139, s28, v11
  v_and_b32 v140, s28, v8
  v_and_b32 v141, s28, v9
  v_and_b32 v142, s28, v10
  v_and_b32 v143, s28, v11
  s_waitcnt vmcnt(23)
  s_barrier
  s_waitcnt vmcnt(9)
  v_perm_b32 v32, v68, v64, s4
  v_perm_b32 v33, v68, v64, s5
  v_perm_b32 v34, v69, v65, s4
  v_perm_b32 v35, v69, v65, s5
  v_perm_b32 v36, v70, v66, s4
  v_perm_b32 v37, v70, v66, s5
  v_perm_b32 v38, v71, v67, s4
  v_perm_b32 v39, v71, v67, s5
  v_dot2c_f32_bf16 v24, v32, v16
  v_dot2c_f32_bf16 v25, v33, v16
  v_dot2c_f32_bf16 v26, v34, v16
  v_dot2c_f32_bf16 v27, v35, v16
  v_dot2c_f32_bf16 v28, v36, v16
  v_dot2c_f32_bf16 v29, v37, v16
  v_dot2c_f32_bf16 v30, v38, v16
  v_dot2c_f32_bf16 v31, v39, v16
  s_waitcnt vmcnt(9)
  v_perm_b32 v32, v76, v72, s4
  v_perm_b32 v33, v76, v72, s5
  v_perm_b32 v34, v77, v73, s4
  v_perm_b32 v35, v77, v73, s5
  v_perm_b32 v36, v78, v74, s4
  v_perm_b32 v37, v78, v74, s5
  v_perm_b32 v38, v79, v75, s4
  v_perm_b32 v39, v79, v75, s5
  v_dot2c_f32_bf16 v24, v32, v17
  v_dot2c_f32_bf16 v25, v33, v17
  v_dot2c_f32_bf16 v26, v34, v17
  v_dot2c_f32_bf16 v27, v35, v17
  v_dot2c_f32_bf16 v28, v36, v17
  v_dot2c_f32_bf16 v29, v37, v17
  v_dot2c_f32_bf16 v30, v38, v17
  v_dot2c_f32_bf16 v31, v39, v17
  s_waitcnt vmcnt(9)
  v_perm_b32 v32, v84, v80, s4
  v_perm_b32 v33, v84, v80, s5
  v_perm_b32 v34, v85, v81, s4
  v_perm_b32 v35, v85, v81, s5
  v_perm_b32 v36, v86, v82, s4
  v_perm_b32 v37, v86, v82, s5
  v_perm_b32 v38, v87, v83, s4
  v_perm_b32 v39, v87, v83, s5
  v_dot2c_f32_bf16 v24, v32, v18
  v_dot2c_f32_bf16 v25, v33, v18
  v_dot2c_f32_bf16 v26, v34, v18
  v_dot2c_f32_bf16 v27, v35, v18
  v_dot2c_f32_bf16 v28, v36, v18
  v_dot2c_f32_bf16 v29, v37, v18
  v_dot2c_f32_bf16 v30, v38, v18
  v_dot2c_f32_bf16 v31, v39, v18
  s_waitcnt vmcnt(9)
  v_perm_b32 v32, v92, v88, s4
  v_perm_b32 v33, v92, v88, s5
  v_perm_b32 v34, v93, v89, s4
  v_perm_b32 v35, v93, v89, s5
  v_perm_b32 v36, v94, v90, s4
  v_perm_b32 v37, v94, v90, s5
  v_perm_b32 v38, v95, v91, s4
  v_perm_b32 v39, v95, v91, s5
  v_dot2c_f32_bf16 v24, v32, v19
  v_dot2c_f32_bf16 v25, v33, v19
  v_dot2c_f32_bf16 v26, v34, v19
  v_dot2c_f32_bf16 v27, v35, v19
  v_dot2c_f32_bf16 v28, v36, v19
  v_dot2c_f32_bf16 v29, v37, v19
  v_dot2c_f32_bf16 v30, v38, v19
  v_dot2c_f32_bf16 v31, v39, v19
  s_waitcnt vmcnt(7)
  v_perm_b32 v32, v100, v96, s4
  v_perm_b32 v33, v100, v96, s5
  v_perm_b32 v34, v101, v97, s4
  v_perm_b32 v35, v101, v97, s5
  v_perm_b32 v36, v102, v98, s4
  v_perm_b32 v37, v102, v98, s5
  v_perm_b32 v38, v103, v99, s4
  v_perm_b32 v39, v103, v99, s5
  v_dot2c_f32_bf16 v24, v32, v20
  v_dot2c_f32_bf16 v25, v33, v20
  v_dot2c_f32_bf16 v26, v34, v20
  v_dot2c_f32_bf16 v27, v35, v20
  v_dot2c_f32_bf16 v28, v36, v20
  v_dot2c_f32_bf16 v29, v37, v20
  v_dot2c_f32_bf16 v30, v38, v20
  v_dot2c_f32_bf16 v31, v39, v20
  s_waitcnt vmcnt(5)
  v_perm_b32 v32, v108, v104, s4
  v_perm_b32 v33, v108, v104, s5
  v_perm_b32 v34, v109, v105, s4
  v_perm_b32 v35, v109, v105, s5
  v_perm_b32 v36, v110, v106, s4
  v_perm_b32 v37, v110, v106, s5
  v_perm_b32 v38, v111, v107, s4
  v_perm_b32 v39, v111, v107, s5
  v_dot2c_f32_bf16 v24, v32, v21
  v_dot2c_f32_bf16 v25, v33, v21
  v_dot2c_f32_bf16 v26, v34, v21
  v_dot2c_f32_bf16 v27, v35, v21
  v_dot2c_f32_bf16 v28, v36, v21
  v_dot2c_f32_bf16 v29, v37, v21
  v_dot2c_f32_bf16 v30, v38, v21
  v_dot2c_f32_bf16 v31, v39, v21
  s_waitcnt vmcnt(3)
  v_perm_b32 v32, v116, v112, s4
  v_perm_b32 v33, v116, v112, s5
  v_perm_b32 v34, v117, v113, s4
  v_perm_b32 v35, v117, v113, s5
  v_perm_b32 v36, v118, v114, s4
  v_perm_b32 v37, v118, v114, s5
  v_perm_b32 v38, v119, v115, s4
  v_perm_b32 v39, v119, v115, s5
  v_dot2c_f32_bf16 v24, v32, v22
  v_dot2c_f32_bf16 v25, v33, v22
  v_dot2c_f32_bf16 v26, v34, v22
  v_dot2c_f32_bf16 v27, v35, v22
  v_dot2c_f32_bf16 v28, v36, v22
  v_dot2c_f32_bf16 v29, v37, v22
  v_dot2c_f32_bf16 v30, v38, v22
  v_dot2c_f32_bf16 v31, v39, v22
  s_waitcnt vmcnt(1)
  v_perm_b32 v32, v124, v120, s4
  v_perm_b32 v33, v124, v120, s5
  v_perm_b32 v34, v125, v121, s4
  v_perm_b32 v35, v125, v121, s5
  v_perm_b32 v36, v126, v122, s4
  v_perm_b32 v37, v126, v122, s5
  v_perm_b32 v38, v127, v123, s4
  v_perm_b32 v39, v127, v123, s5
  v_dot2c_f32_bf16 v24, v32, v23
  v_dot2c_f32_bf16 v25, v33, v23
  v_dot2c_f32_bf16 v26, v34, v23
  v_dot2c_f32_bf16 v27, v35, v23
  v_dot2c_f32_bf16 v28, v36, v23
  v_dot2c_f32_bf16 v29, v37, v23
  v_dot2c_f32_bf16 v30, v38, v23
  v_dot2c_f32_bf16 v31, v39, v23
  s_nop 2
  v_add_f32_dpp v24, v24, v24 row_ror:8 row_mask:0xf bank_mask:0xf
  v_add_f32_dpp v25, v25, v25 row_ror:8 row_mask:0xf bank_mask:0xf
  v_add_f32_dpp v26, v26, v26 row_ror:8 row_mask:0xf bank_mask:0xf
  v_add_f32_dpp v27, v27, v27 row_ror:8 row_mask:0xf bank_mask:0xf
  v_add_f32_dpp v28, v28, v28 row_ror:8 row_mask:0xf bank_mask:0xf
  v_add_f32_dpp v29, v29, v29 row_ror:8 row_mask:0xf bank_mask:0xf
  v_add_f32_dpp v30, v30, v30 row_ror:8 row_mask:0xf bank_mask:0xf
  v_add_f32_dpp v31, v31, v31 row_ror:8 row_mask:0xf bank_mask:0xf
  ds_write_b128 v60, v[24:27] offset:13056
  ds_write_b128 v60, v[28:31] offset:13072
  s_waitcnt vmcnt(0) lgkmcnt(0)
  s_barrier
  s_cmp_lg_u32 s3, 0
  s_cbranch_scc1 L_T_QPOLL
  ds_read_b128 v[32:35], v14 offset:13056
  ds_read_b128 v[36:39], v14 offset:13312
  ds_read_b128 v[40:43], v14 offset:13568
  ds_read_b128 v[44:47], v14 offset:13824
  s_waitcnt lgkmcnt(0)
  v_pk_add_f32 v[32:33], v[32:33], v[36:37]
  v_pk_add_f32 v[34:35], v[34:35], v[38:39]
  v_pk_add_f32 v[40:41], v[40:41], v[44:45]
  v_pk_add_f32 v[42:43], v[42:43], v[46:47]
  v_pk_add_f32 v[32:33], v[32:33], v[40:41]
  v_pk_add_f32 v[34:35], v[34:35], v[42:43]
  v_mov_b32 v36, v32
  v_mov_b32 v37, v33
  v_mov_b32 v38, v34
  v_mov_b32 v39, v35
  v_permlane16_swap_b32 v32, v36
  v_permlane16_swap_b32 v33, v37
  v_permlane16_swap_b32 v34, v38
  v_permlane16_swap_b32 v35, v39
  v_pk_add_f32 v[32:33], v[32:33], v[36:37]
  v_pk_add_f32 v[34:35], v[34:35], v[38:39]
  v_mov_b32 v36, v32
  v_mov_b32 v37, v33
  v_mov_b32 v38, v34
  v_mov_b32 v39, v35
  v_permlane32_swap_b32 v32, v36
  v_permlane32_swap_b32 v33, v37
  v_permlane32_swap_b32 v34, v38
  v_permlane32_swap_b32 v35, v39
  v_pk_add_f32 v[32:33], v[32:33], v[36:37]
  v_pk_add_f32 v[34:35], v[34:35], v[38:39]
  v_add_u32 v32, 0x80, v32
  v_add_u32 v33, 0x80, v33
  v_add_u32 v34, 0x80, v34
  v_add_u32 v35, 0x80, v35
  v_bfi_b32 v32, s28, v8, v32
  v_bfi_b32 v33, s28, v9, v33
  v_bfi_b32 v34, s28, v10, v34
  v_bfi_b32 v35, s28, v11, v35
  s_mov_b64 exec, 0xffff
  buffer_store_dwordx4 v[32:35], v12, s[52:55], s29 offen sc1
  s_mov_b64 exec, -1
L_T_QPOLL:
  s_lshr_b32 s36, s2, 5
  s_lshl_b32 s36, s36, 3
  s_or_b32 s36, s36, s87
  s_bfe_u32 s37, s2, 0x20003
  s_and_b32 s89, s2, 1
  s_lshl_b32 s89, s89, 2
  s_add_u32 s89, s89, s3
  s_lshr_b32 s38, s36, 1
  s_lshl_b32 s85, s38, 2
  s_lshr_b32 s10, s89, 1
  s_add_u32 s85, s85, s10
  s_lshl_b32 s85, s85, 5
  s_and_b32 s10, s89, 1
  s_lshl_b32 s10, s10, 2
  s_add_u32 s85, s85, s10
  s_lshl_b32 s85, s85, 11
  s_lshl_b32 s10, s37, 9
  s_add_u32 s85, s85, s10
  v_bfe_u32 v2, v1, 4, 1
  v_lshrrev_b32 v3, 5, v1
  v_and_b32 v4, 15, v1
  v_lshlrev_b32 v249, 12, v2
  v_lshl_add_u32 v249, v3, 8, v249
  v_lshl_add_u32 v249, v4, 4, v249
  v_lshlrev_b32 v3, 3, v3
  v_sub_u32 v236, v4, v3
  v_lshlrev_b32 v236, 5, v236
  v_lshl_add_u32 v236, v2, 4, v236
  s_lshl_b32 s10, s3, 10
  s_add_u32 s11, s10, 512
  v_add_u32 v236, s11, v236
  v_lshlrev_b32 v239, 4, v1
  v_add_u32 v239, 13056, v239
  v_add_u32 v237, s10, v239
  v_mov_b32 v238, 16
  s_and_b32 s10, s36, 15
  v_lshrrev_b32 v2, 2, v1
  v_xor_b32 v2, s10, v2
  v_and_b32 v3, 3, v1
  v_lshlrev_b32 v3, 4, v3
  v_lshl_add_u32 v244, v2, 6, v3
  s_lshr_b32 s10, s36, 4
  s_xor_b32 s10, s10, s37
  s_lshl_b32 s10, s10, 10
  s_lshl_b32 s84, s36, 12
  s_add_u32 s84, s84, s10
  s_add_u32 s84, s84, 262144
  s_mov_b32 s12, 1023
  v_and_b32 v6, 3, v1
  v_lshrrev_b32 v2, 4, v1
  v_lshl_add_u32 v29, v6, 2, v2
  v_lshlrev_b32 v29, 1, v29
  s_lshl_b32 s10, s3, 10
  s_add_u32 s10, s10, 4832
  v_add_u32 v29, s10, v29
  v_lshlrev_b32 v31, 4, v6
  v_lshl_add_u32 v21, v2, 1, v31
  v_lshrrev_b32 v20, 2, v1
  v_lshl_add_u32 v2, v20, 12, v31
  s_and_b32 s39, s38, 7
  s_lshl_b32 s39, s39, 3
  s_add_u32 s39, s39, s89
  s_and_b32 s10, s39, 15
  v_xor_b32 v19, s10, v20
  v_lshl_add_u32 v19, v19, 6, v2
  s_and_b32 s10, s36, 15
  v_xor_b32 v22, s10, v20
  v_lshl_add_u32 v22, v22, 6, v2
  s_lshl_b32 s49, s3, 18
  s_add_u32 s49, s49, 262144
  s_lshr_b32 s11, s36, 4
  s_xor_b32 s10, s11, 3
  s_lshl_b32 s10, s10, 10
  s_add_u32 s10, s10, 196608
  s_add_u32 s35, s49, s10
  s_xor_b32 s10, s11, 2
  s_lshl_b32 s10, s10, 10
  s_add_u32 s10, s10, 131072
  s_add_u32 s34, s49, s10
  s_xor_b32 s10, s11, 1
  s_lshl_b32 s10, s10, 10
  s_add_u32 s10, s10, 65536
  s_add_u32 s31, s49, s10
  s_xor_b32 s10, s11, 0
  s_lshl_b32 s10, s10, 10
  s_add_u32 s30, s49, s10
  s_lshl_b32 s49, s6, 18
  s_add_u32 s49, s49, 1048576
  s_lshr_b32 s11, s39, 4
  s_xor_b32 s10, s11, 3
  s_lshl_b32 s10, s10, 10
  s_add_u32 s10, s10, 196608
  s_add_u32 s47, s49, s10
  s_xor_b32 s10, s11, 2
  s_lshl_b32 s10, s10, 10
  s_add_u32 s10, s10, 131072
  s_add_u32 s46, s49, s10
  s_xor_b32 s10, s11, 1
  s_lshl_b32 s10, s10, 10
  s_add_u32 s10, s10, 65536
  s_add_u32 s45, s49, s10
  s_xor_b32 s10, s11, 0
  s_lshl_b32 s10, s10, 10
  s_add_u32 s44, s49, s10
  s_lshl_b32 s49, s6, 16
  s_add_u32 s49, s49, 786432
  s_lshr_b32 s11, s39, 4
  s_xor_b32 s10, s11, 1
  s_lshl_b32 s10, s10, 10
  s_add_u32 s10, s10, 32768
  s_add_u32 s73, s49, s10
  s_xor_b32 s10, s11, 0
  s_lshl_b32 s10, s10, 10
  s_add_u32 s81, s49, s10
  s_lshr_b32 s69, s36, 3
  s_lshl_b32 s69, s69, 8
  s_and_b32 s10, s36, 3
  s_lshl_b32 s10, s10, 6
  s_add_u32 s69, s69, s10
  s_and_b32 s10, s36, 4
  s_lshl_b32 s10, s10, 1
  s_add_u32 s69, s69, s10
  s_lshl_b32 s10, s3, 11
  s_add_u32 s69, s69, s10
  s_lshl_b32 s10, s42, 4
  s_add_u32 s10, s10, s86
  s_lshl_b32 s11, s42, 3
  s_add_u32 s11, s11, s86
  v_mov_b32 v240, 4
  v_lshrrev_b32 v245, 5, v0
  v_add_u32 v241, v0, v245
  v_lshlrev_b32 v241, 4, v241
  v_add_u32 v241, 38144, v241
  v_lshlrev_b32 v242, 3, v245
  v_add_u32 v242, 12800, v242
  v_lshrrev_b32 v245, 2, v0
  v_xor_b32 v245, s10, v245
  v_and_b32 v246, 3, v0
  v_lshlrev_b32 v246, 4, v246
  v_lshl_add_u32 v243, v245, 6, v246
  s_bfe_u32 s80, s91, 0x60008
  s_add_u32 s79, s91, 2869
  s_bfe_u32 s79, s79, 0x60008
  s_lshl_b32 s79, s79, 8
  s_or_b32 s80, s80, s79
  s_add_u32 s79, s91, 9617
  s_bfe_u32 s79, s79, 0x60008
  s_lshl_b32 s79, s79, 16
  s_or_b32 s80, s80, s79
  s_add_u32 s79, s91, 1383
  s_bfe_u32 s79, s79, 0x60008
  s_lshl_b32 s79, s79, 24
  s_or_b32 s80, s80, s79
  v_mov_b32 v245, s80
  v_mov_b32 v246, 0x3fff
  v_mov_b32 v250, 202114048
  v_mov_b32 v251, 202114305
  v_mov_b32 v252, 202114562
  v_mov_b32 v253, 202114819
  s_lshl_b32 s79, s11, 12
  s_lshl_b32 s80, s6, 16
  s_add_u32 s79, s79, s80
  s_add_u32 s79, s79, 786432
  v_and_b32 v160, s28, v8
  v_and_b32 v161, s28, v9
  v_and_b32 v162, s28, v10
  v_and_b32 v163, s28, v11
  s_mov_b32 s15, 0
  s_mov_b64 exec, s[16:17]
  s_cbranch_execz L_T_QP_J0
  buffer_load_dwordx4 v[128:131], v12, s[52:55], s32 offen
L_T_QP_J0:
  s_mov_b64 exec, s[18:19]
  s_cbranch_execz L_T_QP_J1
  buffer_load_dwordx4 v[132:135], v12, s[52:55], s33 offen
L_T_QP_J1:
  s_mov_b64 exec, s[20:21]
  s_cbranch_execz L_T_QP_J2
  buffer_load_dwordx4 v[136:139], v12, s[52:55], s90 offen
L_T_QP_J2:
  s_mov_b64 exec, s[22:23]
  s_cbranch_execz L_T_QP_J3
  buffer_load_dwordx4 v[140:143], v12, s[52:55], s68 offen
L_T_QP_J3:
  s_branch L_T_QP_K3
L_T_QP:
  s_mov_b64 exec, s[16:17]
  s_cbranch_execz L_T_QP_K0
  buffer_load_dwordx4 v[128:131], v12, s[52:55], s32 offen sc1
L_T_QP_K0:
  s_mov_b64 exec, s[18:19]
  s_cbranch_execz L_T_QP_K1
  buffer_load_dwordx4 v[132:135], v12, s[52:55], s33 offen sc1
L_T_QP_K1:
  s_mov_b64 exec, s[20:21]
  s_cbranch_execz L_T_QP_K2
  buffer_load_dwordx4 v[136:139], v12, s[52:55], s90 offen sc1
L_T_QP_K2:
  s_mov_b64 exec, s[22:23]
  s_cbranch_execz L_T_QP_K3
  buffer_load_dwordx4 v[140:143], v12, s[52:55], s68 offen sc1
L_T_QP_K3:
  s_mov_b64 exec, -1
  s_add_u32 s15, s15, 1
  s_waitcnt vmcnt(0)
  v_xor_b32 v144, v128, v160
  v_xor_b32 v145, v129, v161
  v_xor_b32 v146, v130, v162
  v_xor_b32 v147, v131, v163
  v_xor_b32 v148, v132, v160
  v_xor_b32 v149, v133, v161
  v_xor_b32 v150, v134, v162
  v_xor_b32 v151, v135, v163
  v_xor_b32 v152, v136, v160
  v_xor_b32 v153, v137, v161
  v_xor_b32 v154, v138, v162
  v_xor_b32 v155, v139, v163
  v_xor_b32 v156, v140, v160
  v_xor_b32 v157, v141, v161
  v_xor_b32 v158, v142, v162
  v_xor_b32 v159, v143, v163
  v_or3_b32 v176, v144, v145, v146
  v_or3_b32 v177, v148, v149, v150
  v_or3_b32 v178, v152, v153, v154
  v_or3_b32 v179, v156, v157, v158
  v_or_b32 v176, v176, v147
  v_or_b32 v177, v177, v151
  v_or_b32 v178, v178, v155
  v_or_b32 v179, v179, v159
  v_or3_b32 v180, v176, v177, v178
  v_bitop3_b32 v180, v180, v179, s28 bitop3:0xa8
  v_cmp_ne_u32 vcc, 0, v180
  s_cbranch_vccz L_T_QP_D
  v_and_b32 v176, s28, v176
  v_and_b32 v177, s28, v177
  v_and_b32 v178, s28, v178
  v_and_b32 v179, s28, v179
  v_cmp_ne_u32 s[16:17], 0, v176
  v_cmp_ne_u32 s[18:19], 0, v177
  v_cmp_ne_u32 s[20:21], 0, v178
  v_cmp_ne_u32 s[22:23], 0, v179
  s_or_b64 s[10:11], s[16:17], s[18:19]
  s_or_b64 s[76:77], s[20:21], s[22:23]
  s_sleep 2
  s_cmp_lt_u32 s15, 200000
  s_cbranch_scc1 L_T_QP
  v_mov_b32 v176, 1
  buffer_store_dword v176, v7, s[64:67], 0 offen offset:4
L_T_QP_D:
  v_pk_add_f32 v[144:145], v[144:145], v[148:149]
  v_pk_add_f32 v[146:147], v[146:147], v[150:151]
  v_pk_add_f32 v[152:153], v[152:153], v[156:157]
  v_pk_add_f32 v[154:155], v[154:155], v[158:159]
  v_cvt_pk_bf16_f32 v48, v144, v145
  v_cvt_pk_bf16_f32 v49, v146, v147
  v_cvt_pk_bf16_f32 v50, v152, v153
  v_cvt_pk_bf16_f32 v51, v154, v155
  ds_write_b64 v13, v[48:49] offset:8448
  ds_write_b64 v13, v[50:51] offset:10496
  s_waitcnt lgkmcnt(0)
  s_barrier
  s_cmp_eq_u32 s88, 0
  s_cbranch_scc1 L_T_NOPROD
  s_call_b64 s[82:83], L_PRODUCE
L_T_NOPROD:
  s_mov_b32 s43, 0x3f00
  s_mov_b32 s48, 0x0c0c0400
  s_mov_b32 s49, 0xffffc000
  v_and_b32 v128, s43, v8
  v_or_b32 v128, 255, v128
  v_and_b32 v129, s43, v9
  v_or_b32 v129, 255, v129
  v_and_b32 v130, s43, v10
  v_or_b32 v130, 127, v130
  v_and_b32 v131, s43, v11
  v_or_b32 v131, 255, v131
  v_mov_b32 v132, v128
  v_mov_b32 v133, v129
  v_mov_b32 v134, v130
  v_mov_b32 v135, v131
  v_mov_b32 v136, v128
  v_mov_b32 v137, v129
  v_mov_b32 v138, v130
  v_mov_b32 v139, v131
  v_mov_b32 v140, v128
  v_mov_b32 v141, v129
  v_mov_b32 v142, v130
  v_mov_b32 v143, v131
  v_mov_b32 v23, 1
  s_mov_b32 s16, -1
  s_mov_b32 s17, 0
  s_mov_b64 s[18:19], s[16:17]
  s_mov_b64 s[20:21], 0
  s_mov_b64 s[22:23], 0
  s_mov_b32 s70, 1
  s_mov_b32 s15, 0
L_T_W3:
  ds_read_b32 v30, v7 offset:24
  s_add_u32 s15, s15, 1
  s_waitcnt lgkmcnt(0)
  v_readfirstlane_b32 s10, v30
  s_nop 0
  s_cmp_ge_u32 s10, 24
  s_cbranch_scc1 L_T_W3_D
  s_sleep 8
  s_cmp_lt_u32 s15, 1600000
  s_cbranch_scc1 L_T_W3
L_T_W3_D:
L_T_PHASE:
  v_and_b32 v160, s43, v8
  v_and_b32 v161, s43, v9
  v_and_b32 v162, s43, v10
  v_and_b32 v163, s43, v11
  s_mov_b32 s15, 0
  s_mov_b64 exec, s[16:17]
  s_cbranch_execz L_T_G1_J0
  buffer_load_dwordx4 v[128:131], v19, s[52:55], s81 offen
L_T_G1_J0:
  s_mov_b64 exec, s[18:19]
  s_cbranch_execz L_T_G1_J1
  buffer_load_dwordx4 v[132:135], v19, s[52:55], s73 offen
L_T_G1_J1:
  s_mov_b64 exec, s[20:21]
  s_cbranch_execz L_T_G1_J2
  buffer_load_dwordx4 v[136:139], v19, s[52:55], s74 offen
L_T_G1_J2:
  s_mov_b64 exec, s[22:23]
  s_cbranch_execz L_T_G1_J3
  buffer_load_dwordx4 v[140:143], v19, s[52:55], s75 offen
L_T_G1_J3:
  s_branch L_T_G1_K3
L_T_G1:
  s_mov_b64 exec, s[16:17]
  s_cbranch_execz L_T_G1_K0
  buffer_load_dwordx4 v[128:131], v19, s[52:55], s81 offen sc1
L_T_G1_K0:
  s_mov_b64 exec, s[18:19]
  s_cbranch_execz L_T_G1_K1
  buffer_load_dwordx4 v[132:135], v19, s[52:55], s73 offen sc1
L_T_G1_K1:
  s_mov_b64 exec, s[20:21]
  s_cbranch_execz L_T_G1_K2
  buffer_load_dwordx4 v[136:139], v19, s[52:55], s74 offen sc1
L_T_G1_K2:
  s_mov_b64 exec, s[22:23]
  s_cbranch_execz L_T_G1_K3
  buffer_load_dwordx4 v[140:143], v19, s[52:55], s75 offen sc1
L_T_G1_K3:
  s_mov_b64 exec, -1
  s_add_u32 s15, s15, 1
  s_waitcnt vmcnt(0)
  v_xor_b32 v144, v128, v160
  v_xor_b32 v145, v129, v161
  v_xor_b32 v146, v130, v162
  v_xor_b32 v147, v131, v163
  v_xor_b32 v148, v132, v160
  v_xor_b32 v149, v133, v161
  v_xor_b32 v150, v134, v162
  v_xor_b32 v151, v135, v163
  v_xor_b32 v152, v136, v160
  v_xor_b32 v153, v137, v161
  v_xor_b32 v154, v138, v162
  v_xor_b32 v155, v139, v163
  v_xor_b32 v156, v140, v160
  v_xor_b32 v157, v141, v161
  v_xor_b32 v158, v142, v162
  v_xor_b32 v159, v143, v163
  v_or3_b32 v176, v144, v145, v146
  v_or3_b32 v177, v148, v149, v150
  v_or3_b32 v178, v152, v153, v154
  v_or3_b32 v179, v156, v157, v158
  v_or_b32 v176, v176, v147
  v_or_b32 v177, v177, v151
  v_or_b32 v178, v178, v155
  v_or_b32 v179, v179, v159
  v_or3_b32 v180, v176, v177, v178
  v_bitop3_b32 v180, v180, v179, s43 bitop3:0xa8
  v_cmp_ne_u32 vcc, 0, v180
  v_perm_b32 v184, v129, v128, s48
  v_perm_b32 v185, v131, v130, s48
  v_perm_b32 v186, v133, v132, s48
  v_perm_b32 v187, v135, v134, s48
  v_perm_b32 v188, v137, v136, s48
  v_perm_b32 v189, v139, v138, s48
  v_perm_b32 v190, v141, v140, s48
  v_perm_b32 v191, v143, v142, s48
  s_cbranch_vccz L_T_G1_D
  v_and_b32 v176, s43, v176
  v_and_b32 v177, s43, v177
  v_and_b32 v178, s43, v178
  v_and_b32 v179, s43, v179
  v_or_b32_dpp v176, v176, v176 quad_perm:[1,0,3,2] row_mask:0xf bank_mask:0xf
  v_or_b32_dpp v177, v177, v177 quad_perm:[1,0,3,2] row_mask:0xf bank_mask:0xf
  v_or_b32_dpp v178, v178, v178 quad_perm:[1,0,3,2] row_mask:0xf bank_mask:0xf
  v_or_b32_dpp v179, v179, v179 quad_perm:[1,0,3,2] row_mask:0xf bank_mask:0xf
  v_or_b32_dpp v176, v176, v176 quad_perm:[2,3,0,1] row_mask:0xf bank_mask:0xf
  v_or_b32_dpp v177, v177, v177 quad_perm:[2,3,0,1] row_mask:0xf bank_mask:0xf
  v_or_b32_dpp v178, v178, v178 quad_perm:[2,3,0,1] row_mask:0xf bank_mask:0xf
  v_or_b32_dpp v179, v179, v179 quad_perm:[2,3,0,1] row_mask:0xf bank_mask:0xf
  v_cmp_ne_u32 s[16:17], 0, v176
  v_cmp_ne_u32 s[18:19], 0, v177
  v_cmp_ne_u32 s[20:21], 0, v178
  v_cmp_ne_u32 s[22:23], 0, v179
  s_or_b64 s[10:11], s[16:17], s[18:19]
  s_or_b64 s[76:77], s[20:21], s[22:23]
  s_bcnt1_i32_b64 s71, s[10:11]
  s_bcnt1_i32_b64 s72, s[76:77]
  s_add_u32 s71, s71, s72
  s_cmp_le_u32 s71, 16
  s_cbranch_scc1 L_T_G1_F
  s_sleep 6
L_T_G1_F:
  s_sleep 1
  s_cmp_lt_u32 s15, 200000
  s_cbranch_scc1 L_T_G1
  v_mov_b32 v176, 2
  buffer_store_dword v176, v7, s[64:67], 0 offen offset:8
L_T_G1_D:
  v_lshl_or_b32 v184, v185, 16, v184
  v_lshl_or_b32 v186, v187, 16, v186
  v_lshl_or_b32 v188, v189, 16, v188
  v_lshl_or_b32 v190, v191, 16, v190
  v_max3_f32 v56, v184, v186, v188
  v_max_f32 v56, v56, v190
  s_nop 1
  v_max_f32_dpp v56, v56, v56 row_ror:4 row_mask:0xf bank_mask:0xf
  s_nop 1
  v_max_f32_dpp v56, v56, v56 row_ror:8 row_mask:0xf bank_mask:0xf
  v_mov_b32 v57, v56
  s_nop 1
  v_permlane16_swap_b32 v56, v57
  v_max_f32 v56, v56, v57
  v_mov_b32 v57, v56
  s_nop 1
  v_permlane32_swap_b32 v56, v57
  v_max_f32 v56, v56, v57
  v_sub_f32 v184, v184, v56
  v_sub_f32 v186, v186, v56
  v_sub_f32 v188, v188, v56
  v_sub_f32 v190, v190, v56
  v_exp_f32 v184, v184
  v_exp_f32 v186, v186
  v_exp_f32 v188, v188
  v_exp_f32 v190, v190
  v_add_f32 v36, v184, v186
  v_add_f32 v37, v188, v190
  v_pk_mul_f32 v[32:33], v[144:145], v[184:185] op_sel_hi:[1,0]
  v_pk_mul_f32 v[34:35], v[146:147], v[184:185] op_sel_hi:[1,0]
  v_add_f32 v36, v36, v37
  v_pk_fma_f32 v[32:33], v[148:149], v[186:187], v[32:33] op_sel_hi:[1,0,1]
  v_pk_fma_f32 v[34:35], v[150:151], v[186:187], v[34:35] op_sel_hi:[1,0,1]
  v_add_f32_dpp v36, v36, v36 row_ror:4 row_mask:0xf bank_mask:0xf
  v_pk_fma_f32 v[32:33], v[152:153], v[188:189], v[32:33] op_sel_hi:[1,0,1]
  v_pk_fma_f32 v[34:35], v[154:155], v[188:189], v[34:35] op_sel_hi:[1,0,1]
  v_add_f32_dpp v36, v36, v36 row_ror:8 row_mask:0xf bank_mask:0xf
  v_pk_fma_f32 v[32:33], v[156:157], v[190:191], v[32:33] op_sel_hi:[1,0,1]
  v_pk_fma_f32 v[34:35], v[158:159], v[190:191], v[34:35] op_sel_hi:[1,0,1]
  v_mov_b32 v37, v36
  v_permlane16_swap_b32 v32, v33
  v_permlane16_swap_b32 v34, v35
  v_permlane16_swap_b32 v36, v37
  v_add_f32 v32, v32, v33
  v_add_f32 v34, v34, v35
  v_add_f32 v36, v36, v37
  v_mov_b32 v37, v36
  v_permlane32_swap_b32 v32, v34
  v_add_f32 v32, v32, v34
  v_permlane32_swap_b32 v36, v37
  v_add_f32 v36, v36, v37
  v_add_f32_dpp v32, v32, v32 row_ror:4 row_mask:0xf bank_mask:0xf
  v_rcp_f32 v36, v36
  s_nop 0
  v_add_f32_dpp v32, v32, v32 row_ror:8 row_mask:0xf bank_mask:0xf
  v_mul_f32 v32, v32, v36
  v_cvt_pk_bf16_f32 v32, v32, v32
  s_cmp_eq_u32 s70, 0
  ds_write_b16 v29, v32
  s_cbranch_scc1 L_T_AOUT
  s_mov_b64 exec, 1
  ds_add_u32 v7, v23 offset:8
  s_mov_b64 exec, -1
  v_subrev_u32 v29, 4096, v29
  s_mov_b32 s81, s44
  s_mov_b64 s[16:17], -1
  s_mov_b32 s73, s45
  s_mov_b64 s[18:19], -1
  s_mov_b32 s74, s46
  s_mov_b64 s[20:21], -1
  s_mov_b32 s75, s47
  s_mov_b64 s[22:23], -1
  s_mov_b32 s70, 0
  s_mov_b32 s15, 0
L_T_W5:
  ds_read_b32 v30, v7 offset:24
  s_add_u32 s15, s15, 1
  s_waitcnt lgkmcnt(0)
  v_readfirstlane_b32 s10, v30
  s_nop 0
  s_cmp_ge_u32 s10, 1024
  s_cbranch_scc1 L_T_W5_D
  s_sleep 3
  s_cmp_lt_u32 s15, 1600000
  s_cbranch_scc1 L_T_W5
L_T_W5_D:
  s_call_b64 s[82:83], L_WOLD
  s_waitcnt vmcnt(0)
  s_call_b64 s[82:83], L_WPERM
  s_mov_b32 s15, 0
L_T_W6:
  ds_read_b32 v30, v7 offset:0
  s_add_u32 s15, s15, 1
  s_waitcnt lgkmcnt(0)
  v_readfirstlane_b32 s10, v30
  s_nop 0
  s_cmp_ge_u32 s10, 4
  s_cbranch_scc1 L_T_W6_D
  s_sleep 2
  s_cmp_lt_u32 s15, 1600000
  s_cbranch_scc1 L_T_W6
L_T_W6_D:
  s_branch L_T_PHASE
L_T_AOUT:
  s_call_b64 s[82:83], L_OUT
  s_lshr_b32 s10, s3, 1
  s_or_b32 s10, s10, s37
  s_cmp_lg_u32 s10, 0
  s_cbranch_scc1 L_T_FIN
  s_mov_b64 s[16:17], -1
  s_mov_b64 s[18:19], -1
  s_mov_b64 s[20:21], -1
  s_mov_b64 s[22:23], -1
  s_mov_b32 s26, 0x000f000f
  s_mov_b32 s27, 0x000f000f
  s_mov_b32 s15, 0
L_T_W8:
  ds_read_b32 v30, v7 offset:16
  s_add_u32 s15, s15, 1
  s_waitcnt lgkmcnt(0)
  v_readfirstlane_b32 s10, v30
  s_nop 0
  s_cmp_ge_u32 s10, 4
  s_cbranch_scc1 L_T_W8_D
  s_sleep 1
  s_cmp_lt_u32 s15, 1600000
  s_cbranch_scc1 L_T_W8
L_T_W8_D:
  s_mov_b32 s15, 0
L_T_W9:
  ds_read_b32 v30, v7 offset:20
  s_add_u32 s15, s15, 1
  s_waitcnt lgkmcnt(0)
  v_readfirstlane_b32 s10, v30
  s_nop 0
  s_cmp_ge_u32 s10, 4
  s_cbranch_scc1 L_T_W9_D
  s_sleep 1
  s_cmp_lt_u32 s15, 1600000
  s_cbranch_scc1 L_T_W9
L_T_W9_D:
  v_and_b32 v160, s12, v8
  v_and_b32 v161, s12, v9
  v_and_b32 v162, s12, v10
  v_and_b32 v163, s12, v11
  s_mov_b32 s15, 0
L_T_G2:
  s_mov_b64 exec, s[16:17]
  s_cbranch_execz L_T_G2_K0
  buffer_load_dwordx4 v[128:131], v22, s[52:55], s30 offen sc1
L_T_G2_K0:
  s_mov_b64 exec, s[18:19]
  s_cbranch_execz L_T_G2_K1
  buffer_load_dwordx4 v[132:135], v22, s[52:55], s31 offen sc1
L_T_G2_K1:
  s_mov_b64 exec, s[20:21]
  s_cbranch_execz L_T_G2_K2
  buffer_load_dwordx4 v[136:139], v22, s[52:55], s34 offen sc1
L_T_G2_K2:
  s_mov_b64 exec, s[22:23]
  s_cbranch_execz L_T_G2_K3
  buffer_load_dwordx4 v[140:143], v22, s[52:55], s35 offen sc1
L_T_G2_K3:
  s_mov_b64 exec, -1
  s_add_u32 s15, s15, 1
  s_waitcnt vmcnt(0)
  v_xor_b32 v144, v128, v160
  v_xor_b32 v145, v129, v161
  v_xor_b32 v146, v130, v162
  v_xor_b32 v147, v131, v163
  v_xor_b32 v148, v132, v160
  v_xor_b32 v149, v133, v161
  v_xor_b32 v150, v134, v162
  v_xor_b32 v151, v135, v163
  v_xor_b32 v152, v136, v160
  v_xor_b32 v153, v137, v161
  v_xor_b32 v154, v138, v162
  v_xor_b32 v155, v139, v163
  v_xor_b32 v156, v140, v160
  v_xor_b32 v157, v141, v161
  v_xor_b32 v158, v142, v162
  v_xor_b32 v159, v143, v163
  v_or3_b32 v176, v144, v145, v146
  v_or3_b32 v177, v148, v149, v150
  v_or3_b32 v178, v152, v153, v154
  v_or3_b32 v179, v156, v157, v158
  v_or_b32 v176, v176, v147
  v_or_b32 v177, v177, v151
  v_or_b32 v178, v178, v155
  v_or_b32 v179, v179, v159
  v_or3_b32 v180, v176, v177, v178
  v_bitop3_b32 v180, v180, v179, s12 bitop3:0xa8
  v_cmp_ne_u32 vcc, 0, v180
  s_cbranch_vccz L_T_G2_D
  v_and_b32 v176, s12, v176
  v_and_b32 v177, s12, v177
  v_and_b32 v178, s12, v178
  v_and_b32 v179, s12, v179
  v_cmp_ne_u32 s[16:17], 0, v176
  v_cmp_ne_u32 s[18:19], 0, v177
  v_cmp_ne_u32 s[20:21], 0, v178
  v_cmp_ne_u32 s[22:23], 0, v179
  s_or_b64 s[10:11], s[16:17], s[18:19]
  s_or_b64 s[76:77], s[20:21], s[22:23]
  s_sleep 1
  s_cmp_lt_u32 s15, 200000
  s_cbranch_scc1 L_T_G2
  v_mov_b32 v176, 3
  buffer_store_dword v176, v7, s[64:67], 0 offen offset:12
L_T_G2_D:
  v_pk_add_f32 v[144:145], v[144:145], v[148:149]
  v_pk_add_f32 v[146:147], v[146:147], v[150:151]
  v_pk_add_f32 v[152:153], v[152:153], v[156:157]
  v_pk_add_f32 v[154:155], v[154:155], v[158:159]
  v_pk_add_f32 v[144:145], v[144:145], v[152:153]
  v_pk_add_f32 v[146:147], v[146:147], v[154:155]
  s_nop 0
  v_permlane16_swap_b32 v144, v145
  v_permlane16_swap_b32 v146, v147
  v_add_f32 v144, v144, v145
  v_add_f32 v146, v146, v147
  s_nop 1
  v_permlane32_swap_b32 v144, v146
  v_add_f32 v144, v144, v146
  s_nop 1
  v_add_f32_dpp v144, v144, v144 row_ror:4 row_mask:0xf bank_mask:0xf
  s_nop 1
  v_add_f32_dpp v144, v144, v144 row_ror:8 row_mask:0xf bank_mask:0xf
  v_cvt_pk_bf16_f32 v144, v144, v144
  s_mov_b64 exec, s[26:27]
  buffer_store_short v144, v21, s[60:63], s69 offen sc1
  s_mov_b64 exec, 1
  s_or_b32 s10, s2, s3
  s_cmp_lg_u32 s10, 0
  s_cbranch_scc1 L_T_NOEP
  buffer_store_dword v8, v7, s[52:55], 0 offen sc1
L_T_NOEP:
L_T_FIN:
  s_endpgm
L_WOLD:
  s_mov_b32 s10, s85
  buffer_load_dwordx4 v[192:195], v249, s[56:59], s10 offen nt
  buffer_load_dwordx4 v[208:211], v249, s[56:59], s10 offen offset:2048 nt
  s_add_u32 s10, s10, 16384
  buffer_load_dwordx4 v[196:199], v249, s[56:59], s10 offen nt
  buffer_load_dwordx4 v[212:215], v249, s[56:59], s10 offen offset:2048 nt
  s_add_u32 s10, s10, 16384
  buffer_load_dwordx4 v[200:203], v249, s[56:59], s10 offen nt
  buffer_load_dwordx4 v[216:219], v249, s[56:59], s10 offen offset:2048 nt
  s_add_u32 s10, s10, 16384
  buffer_load_dwordx4 v[204:207], v249, s[56:59], s10 offen nt
  buffer_load_dwordx4 v[220:223], v249, s[56:59], s10 offen offset:2048 nt
  s_setpc_b64 s[82:83]
L_WPERM:
  v_perm_b32 v96, v196, v192, s4
  v_perm_b32 v97, v204, v200, s4
  v_perm_b32 v98, v212, v208, s4
  v_perm_b32 v99, v220, v216, s4
  v_perm_b32 v100, v196, v192, s5
  v_perm_b32 v101, v204, v200, s5
  v_perm_b32 v102, v212, v208, s5
  v_perm_b32 v103, v220, v216, s5
  v_perm_b32 v104, v197, v193, s4
  v_perm_b32 v105, v205, v201, s4
  v_perm_b32 v106, v213, v209, s4
  v_perm_b32 v107, v221, v217, s4
  v_perm_b32 v108, v197, v193, s5
  v_perm_b32 v109, v205, v201, s5
  v_perm_b32 v110, v213, v209, s5
  v_perm_b32 v111, v221, v217, s5
  v_perm_b32 v112, v198, v194, s4
  v_perm_b32 v113, v206, v202, s4
  v_perm_b32 v114, v214, v210, s4
  v_perm_b32 v115, v222, v218, s4
  v_perm_b32 v116, v198, v194, s5
  v_perm_b32 v117, v206, v202, s5
  v_perm_b32 v118, v214, v210, s5
  v_perm_b32 v119, v222, v218, s5
  v_perm_b32 v120, v199, v195, s4
  v_perm_b32 v121, v207, v203, s4
  v_perm_b32 v122, v215, v211, s4
  v_perm_b32 v123, v223, v219, s4
  v_perm_b32 v124, v199, v195, s5
  v_perm_b32 v125, v207, v203, s5
  v_perm_b32 v126, v215, v211, s5
  v_perm_b32 v127, v223, v219, s5
  s_setpc_b64 s[82:83]
L_OUT:
  ds_read_b128 v[144:147], v236 offset:224
  ds_read_b128 v[148:151], v236 offset:192
  ds_read_b128 v[152:155], v236 offset:160
  ds_read_b128 v[156:159], v236 offset:128
  ds_read_b128 v[160:163], v236 offset:96
  ds_read_b128 v[164:167], v236 offset:64
  ds_read_b128 v[168:171], v236 offset:32
  ds_read_b128 v[172:175], v236 offset:0
  v_mov_b32 v44, 1
  s_waitcnt lgkmcnt(7)
  v_mfma_f32_16x16x32_bf16 v[32:35], v[144:147], v[96:99], 0
  s_waitcnt lgkmcnt(6)
  v_mfma_f32_16x16x32_bf16 v[32:35], v[148:151], v[100:103], v[32:35]
  s_waitcnt lgkmcnt(5)
  v_mfma_f32_16x16x32_bf16 v[32:35], v[152:155], v[104:107], v[32:35]
  s_waitcnt lgkmcnt(4)
  v_mfma_f32_16x16x32_bf16 v[32:35], v[156:159], v[108:111], v[32:35]
  s_waitcnt lgkmcnt(3)
  v_mfma_f32_16x16x32_bf16 v[32:35], v[160:163], v[112:115], v[32:35]
  s_waitcnt lgkmcnt(2)
  v_mfma_f32_16x16x32_bf16 v[32:35], v[164:167], v[116:119], v[32:35]
  s_waitcnt lgkmcnt(1)
  v_mfma_f32_16x16x32_bf16 v[32:35], v[168:171], v[120:123], v[32:35]
  s_waitcnt lgkmcnt(0)
  v_mfma_f32_16x16x32_bf16 v[32:35], v[172:175], v[124:127], v[32:35]
  s_nop 7
  ds_write_b128 v237, v[32:35]
  s_mov_b64 exec, 1
  ds_add_rtn_u32 v45, v238, v44
  s_waitcnt lgkmcnt(0)
  v_readfirstlane_b32 s10, v45
  s_mov_b64 exec, -1
  s_cmp_lg_u32 s10, 3
  s_cbranch_scc1 L_OUT_R
  ds_read_b128 v[32:35], v239 offset:0
  ds_read_b128 v[36:39], v239 offset:1024
  ds_read_b128 v[40:43], v239 offset:2048
  ds_read_b128 v[44:47], v239 offset:3072
  s_waitcnt lgkmcnt(2)
  v_pk_add_f32 v[32:33], v[32:33], v[36:37]
  v_pk_add_f32 v[34:35], v[34:35], v[38:39]
  s_waitcnt lgkmcnt(0)
  v_pk_add_f32 v[40:41], v[40:41], v[44:45]
  v_pk_add_f32 v[42:43], v[42:43], v[46:47]
  v_pk_add_f32 v[32:33], v[32:33], v[40:41]
  v_pk_add_f32 v[34:35], v[34:35], v[42:43]
  v_bfi_b32 v32, s12, v8, v32
  v_bfi_b32 v33, s12, v9, v33
  v_bfi_b32 v34, s12, v10, v34
  v_bfi_b32 v35, s12, v11, v35
  buffer_store_dwordx4 v[32:35], v244, s[52:55], s84 offen sc1
L_OUT_R:
  s_setpc_b64 s[82:83]
L_PRODUCE:
  s_mov_b32 s15, 0
L_P_W1:
  ds_read_b32 v30, v240 offset:0
  s_add_u32 s15, s15, 1
  s_waitcnt lgkmcnt(0)
  v_readfirstlane_b32 s10, v30
  s_nop 0
  s_cmp_ge_u32 s10, 4
  s_cbranch_scc1 L_P_W1_D
  s_sleep 1
  s_cmp_lt_u32 s15, 1600000
  s_cbranch_scc1 L_P_W1
L_P_W1_D:
  ds_read_b64 v[32:33], v242 offset:0
  ds_read_b64 v[34:35], v242 offset:64
  ds_read_b64 v[36:37], v242 offset:128
  ds_read_b64 v[38:39], v242 offset:192
  ds_read_b128 v[40:43], v241 offset:0
  ds_read_b128 v[44:47], v241 offset:4224
  ds_read_b128 v[48:51], v241 offset:8448
  ds_read_b128 v[52:55], v241 offset:12672
  s_waitcnt lgkmcnt(4)
  v_max3_f32 v56, v32, v34, v36
  v_max_f32 v56, v56, v38
  v_sub_f32 v32, v32, v56
  v_sub_f32 v34, v34, v56
  v_sub_f32 v36, v36, v56
  v_sub_f32 v38, v38, v56
  v_exp_f32 v32, v32
  v_exp_f32 v34, v34
  v_exp_f32 v36, v36
  v_exp_f32 v38, v38
  v_mul_f32 v57, v32, v33
  v_fmac_f32 v57, v34, v35
  v_fmac_f32 v57, v36, v37
  v_fmac_f32 v57, v38, v39
  v_rcp_f32 v33, v57
  v_log_f32 v58, v57
  s_waitcnt lgkmcnt(0)
  v_pk_mul_f32 v[40:41], v[40:41], v[32:33] op_sel_hi:[1,0]
  v_pk_mul_f32 v[42:43], v[42:43], v[32:33] op_sel_hi:[1,0]
  v_add_f32 v58, v56, v58
  v_pk_fma_f32 v[40:41], v[44:45], v[34:35], v[40:41] op_sel_hi:[1,0,1]
  v_pk_fma_f32 v[42:43], v[46:47], v[34:35], v[42:43] op_sel_hi:[1,0,1]
  v_pk_fma_f32 v[40:41], v[48:49], v[36:37], v[40:41] op_sel_hi:[1,0,1]
  v_pk_fma_f32 v[42:43], v[50:51], v[36:37], v[42:43] op_sel_hi:[1,0,1]
  v_pk_fma_f32 v[40:41], v[52:53], v[38:39], v[40:41] op_sel_hi:[1,0,1]
  v_pk_fma_f32 v[42:43], v[54:55], v[38:39], v[42:43] op_sel_hi:[1,0,1]
  v_perm_b32 v44, v245, v58, v250
  v_perm_b32 v45, v245, v58, v251
  v_perm_b32 v46, v245, v58, v252
  v_perm_b32 v47, v245, v58, v253
  v_pk_mul_f32 v[40:41], v[40:41], v[32:33] op_sel:[0,1] op_sel_hi:[1,1]
  v_pk_mul_f32 v[42:43], v[42:43], v[32:33] op_sel:[0,1] op_sel_hi:[1,1]
  v_add_u32 v40, 0x2000, v40
  v_add_u32 v41, 0x2000, v41
  v_add_u32 v42, 0x2000, v42
  v_add_u32 v43, 0x2000, v43
  v_bfi_b32 v40, v246, v44, v40
  v_bfi_b32 v41, v246, v45, v41
  v_bfi_b32 v42, v246, v46, v42
  v_bfi_b32 v43, v246, v47, v43
  buffer_store_dwordx4 v[40:43], v243, s[52:55], s79 offen sc1
  s_setpc_b64 s[82:83]
L_S:
  s_mov_b32 s4, 0x05040100
  s_mov_b32 s5, 0x07060302
  s_and_b32 s7, s2, 63
  s_and_b32 s88, s42, 3
  s_cmp_eq_u32 s88, 0
  s_cselect_b32 s88, 1, 0
  s_lshr_b32 s42, s42, 2
  s_sub_u32 s3, s3, 4
  s_setprio 1
  v_subrev_u32 v247, 256, v0
  v_lshlrev_b32 v2, 4, v247
  v_mov_b32 v8, 0
  v_mov_b32 v9, 0
  v_mov_b32 v10, 0
  v_mov_b32 v11, 0
  ds_write_b128 v2, v[8:11]
  ds_write_b128 v2, v[8:11] offset:4096
  ds_write_b128 v2, v[8:11] offset:4352
  v_lshrrev_b32 v6, 4, v1
  v_and_b32 v7, 15, v1
  v_and_b32 v2, 3, v7
  v_lshlrev_b32 v2, 2, v2
  v_lshrrev_b32 v3, 2, v7
  v_add_u32 v2, v2, v3
  v_lshlrev_b32 v2, 8, v2
  s_mul_i32 s77, s3, 24576
  s_add_u32 s77, s77, 55040
  v_add_u32 v2, s77, v2
  v_lshlrev_b32 v3, 2, v6
  v_xor_b32 v3, v3, v7
  v_xor_b32 v4, v6, v7
  v_xor_b32 v5, 0, v3
  v_lshlrev_b32 v5, 4, v5
  v_lshl_add_u32 v224, v6, 8, v5
  v_xor_b32 v5, 0, v4
  v_lshl_add_u32 v228, v5, 4, v2
  v_xor_b32 v5, 1, v3
  v_lshlrev_b32 v5, 4, v5
  v_lshl_add_u32 v225, v6, 8, v5
  v_xor_b32 v5, 4, v4
  v_lshl_add_u32 v229, v5, 4, v2
  v_xor_b32 v5, 2, v3
  v_lshlrev_b32 v5, 4, v5
  v_lshl_add_u32 v226, v6, 8, v5
  v_xor_b32 v5, 8, v4
  v_lshl_add_u32 v230, v5, 4, v2
  v_xor_b32 v5, 3, v3
  v_lshlrev_b32 v5, 4, v5
  v_lshl_add_u32 v227, v6, 8, v5
  v_xor_b32 v5, 12, v4
  v_lshl_add_u32 v231, v5, 4, v2
  v_lshlrev_b32 v4, 4, v1
  v_add_u32 v5, 4096, v4
  v_and_b32 v8, 7, v7
  v_lshlrev_b32 v12, 8, v8
  v_lshl_add_u32 v12, v6, 4, v12
  v_mul_u32_u24 v13, 528, v8
  v_lshl_add_u32 v13, v6, 7, v13
  v_lshlrev_b32 v14, 3, v8
  v_mov_b32 v92, 0
  v_mov_b32 v93, 1
  v_mov_b32 v94, 256
  s_lshl_b32 s8, s6, 24
  s_and_b32 s76, s86, 1
  s_sub_u32 s13, s86, s76
  s_lshl_b32 s9, s13, 18
  s_add_u32 s9, s9, s8
  s_mul_i32 s64, s6, 2
  s_lshl_b32 s65, s86, 1
  s_add_u32 s65, s65, s42
  s_lshl_b32 s65, s65, 3
  s_add_u32 s65, s65, s3
  s_lshl_b32 s65, s65, 13
  s_add_u32 s65, s65, 15728640
  s_add_u32 s65, s65, s8
  s_mov_b32 s67, s88
  s_and_b32 s11, s86, 3
  s_cmp_gt_u32 s87, s11
  s_cselect_b32 s10, 1, 0
  s_sub_u32 s68, s87, s10
  s_add_u32 s11, s11, 4
  s_cmp_gt_u32 s87, s11
  s_cselect_b32 s10, 1, 0
  s_sub_u32 s68, s68, s10
  s_lshl_b32 s68, s68, 2
  s_add_u32 s68, s68, s3
  s_mul_i32 s10, s76, 24
  s_add_u32 s68, s68, s10
  s_lshl_b32 s69, s6, 3
  s_add_u32 s69, s69, s13
  s_lshl_b32 s69, s69, 8
  s_add_u32 s69, s69, 4096
  s_mov_b32 s60, 1069066811
  s_mov_b32 s61, 1069066811
  s_mov_b32 s62, 1035273459
  s_mov_b32 s63, 1035273459
  s_mov_b32 s14, 0xffff0000
  s_mov_b32 s46, 67108864
  s_mov_b32 s47, 0x00020000
  s_mov_b32 s50, 67108864
  s_mov_b32 s51, 0x00020000
  s_lshl_b32 s73, s88, 2
  s_add_u32 s72, s73, s3
  s_lshl_b32 s74, s88, 11
  s_add_u32 s74, s74, 8448
  s_mov_b32 s75, 0
  s_mov_b32 s78, 0
  s_waitcnt lgkmcnt(0)
  s_load_dword s91, s[40:41], 0
  s_mov_b32 s26, 0
  s_cmp_lt_u32 s3, 1
  s_cselect_b32 s27, -1, 68
  s_mov_b32 s52, s40
  s_mov_b32 s53, s41
  s_mov_b32 s54, 2097152
  s_mov_b32 s55, 0x00020000
  s_mov_b32 s56, s34
  s_mov_b32 s57, s35
  s_mov_b32 s58, 8388608
  s_mov_b32 s59, 0x00020000
  s_lshr_b32 s22, s68, 6
  s_add_u32 s22, s22, s64
  s_and_b32 s22, s22, 7
  s_lshl_b32 s22, s22, 8
  s_and_b32 s23, s68, 63
  s_add_u32 s22, s22, s23
  s_lshl_b32 s22, s22, 13
  s_add_u32 s22, s22, s9
  s_cmp_lg_u32 s88, 0
  s_cselect_b32 s44, s28, s18
  s_cselect_b32 s45, s29, s19
  s_cselect_b32 s48, s30, s20
  s_cselect_b32 s49, s31, s21
  s_cselect_b32 s22, s65, s22
  s_add_u32 s65, s65, 32768
  s_add_u32 s23, s22, 4096
  s_barrier
  s_add_u32 m0, s77, 0
  s_nop 0
  buffer_load_dwordx4 v224, s[44:47], s22 offen offset:0 nt lds
  buffer_load_dwordx4 v225, s[44:47], s22 offen offset:1024 nt lds
  buffer_load_dwordx4 v226, s[44:47], s22 offen offset:2048 nt lds
  buffer_load_dwordx4 v227, s[44:47], s22 offen offset:3072 nt lds
  s_add_u32 m0, s77, 4096
  s_nop 0
  buffer_load_dwordx4 v224, s[44:47], s23 offen offset:0 nt lds
  buffer_load_dwordx4 v225, s[44:47], s23 offen offset:1024 nt lds
  buffer_load_dwordx4 v226, s[44:47], s23 offen offset:2048 nt lds
  buffer_load_dwordx4 v227, s[44:47], s23 offen offset:3072 nt lds
  s_waitcnt lgkmcnt(0)
  s_add_u32 s91, s91, 0x101
  v_mov_b32 v240, 0
  v_lshrrev_b32 v245, 5, v247
  v_add_u32 v241, v247, v245
  v_lshlrev_b32 v241, 4, v241
  v_add_u32 v241, 21248, v241
  v_lshlrev_b32 v242, 3, v245
  v_add_u32 v242, 12544, v242
  v_lshrrev_b32 v245, 2, v247
  v_xor_b32 v245, s7, v245
  v_and_b32 v246, 3, v247
  v_lshlrev_b32 v246, 4, v246
  v_lshl_add_u32 v243, v245, 6, v246
  s_bfe_u32 s80, s91, 0x60008
  s_add_u32 s79, s91, 2869
  s_bfe_u32 s79, s79, 0x60008
  s_lshl_b32 s79, s79, 8
  s_or_b32 s80, s80, s79
  s_add_u32 s79, s91, 9617
  s_bfe_u32 s79, s79, 0x60008
  s_lshl_b32 s79, s79, 16
  s_or_b32 s80, s80, s79
  s_add_u32 s79, s91, 1383
  s_bfe_u32 s79, s79, 0x60008
  s_lshl_b32 s79, s79, 24
  s_or_b32 s80, s80, s79
  v_mov_b32 v245, s80
  v_mov_b32 v246, 0x3fff
  v_mov_b32 v250, 202114048
  v_mov_b32 v251, 202114305
  v_mov_b32 v252, 202114562
  v_mov_b32 v253, 202114819
  s_lshl_b32 s79, s7, 12
  s_lshl_b32 s80, s6, 18
  s_add_u32 s79, s79, s80
  s_add_u32 s79, s79, 1048576
  s_lshr_b32 s36, s2, 5
  s_lshl_b32 s36, s36, 3
  s_or_b32 s36, s36, s87
  s_bfe_u32 s37, s2, 0x20003
  s_xor_b32 s37, s37, 1
  s_and_b32 s89, s2, 1
  s_lshl_b32 s89, s89, 2
  s_add_u32 s89, s89, s3
  s_lshr_b32 s38, s36, 1
  s_lshl_b32 s85, s38, 2
  s_lshr_b32 s10, s89, 1
  s_add_u32 s85, s85, s10
  s_lshl_b32 s85, s85, 5
  s_and_b32 s10, s89, 1
  s_lshl_b32 s10, s10, 2
  s_add_u32 s85, s85, s10
  s_lshl_b32 s85, s85, 11
  s_lshl_b32 s10, s37, 9
  s_add_u32 s85, s85, s10
  v_bfe_u32 v2, v1, 4, 1
  v_lshrrev_b32 v3, 5, v1
  v_and_b32 v15, 15, v1
  v_lshlrev_b32 v249, 12, v2
  v_lshl_add_u32 v249, v3, 8, v249
  v_lshl_add_u32 v249, v15, 4, v249
  v_lshlrev_b32 v3, 3, v3
  v_sub_u32 v236, v15, v3
  v_lshlrev_b32 v236, 5, v236
  v_lshl_add_u32 v236, v2, 4, v236
  s_lshl_b32 s10, s3, 10
  s_add_u32 s11, s10, 4608
  v_add_u32 v236, s11, v236
  v_lshlrev_b32 v239, 4, v1
  v_add_u32 v239, 17152, v239
  v_add_u32 v237, s10, v239
  v_mov_b32 v238, 20
  s_and_b32 s10, s36, 15
  v_lshrrev_b32 v2, 2, v1
  v_xor_b32 v2, s10, v2
  v_and_b32 v3, 3, v1
  v_lshlrev_b32 v3, 4, v3
  v_lshl_add_u32 v244, v2, 6, v3
  s_lshr_b32 s10, s36, 4
  s_xor_b32 s10, s10, s37
  s_lshl_b32 s10, s10, 10
  s_lshl_b32 s84, s36, 12
  s_add_u32 s84, s84, s10
  s_add_u32 s84, s84, 524288
  s_mov_b32 s12, 1023
  s_barrier
  s_mov_b32 s16, s22
  s_add_u32 s68, s68, 48
  s_lshr_b32 s22, s68, 6
  s_add_u32 s22, s22, s64
  s_and_b32 s22, s22, 7
  s_lshl_b32 s22, s22, 8
  s_and_b32 s23, s68, 63
  s_add_u32 s22, s22, s23
  s_lshl_b32 s22, s22, 13
  s_add_u32 s22, s22, s9
  s_cmp_lg_u32 s88, 0
  s_cselect_b32 s44, s28, s18
  s_cselect_b32 s45, s29, s19
  s_cselect_b32 s48, s30, s20
  s_cselect_b32 s49, s31, s21
  s_cselect_b32 s22, s65, s22
  s_add_u32 s65, s65, 32768
  s_add_u32 s23, s22, 4096
  s_mov_b32 s17, s22
  s_waitcnt vmcnt(4)
  s_add_u32 m0, s77, 8192
  s_nop 0
  buffer_load_dwordx4 v224, s[44:47], s22 offen offset:0 nt lds
  buffer_load_dwordx4 v225, s[44:47], s22 offen offset:1024 nt lds
  buffer_load_dwordx4 v226, s[44:47], s22 offen offset:2048 nt lds
  buffer_load_dwordx4 v227, s[44:47], s22 offen offset:3072 nt lds
  s_add_u32 m0, s77, 12288
  s_nop 0
  buffer_load_dwordx4 v224, s[44:47], s23 offen offset:0 nt lds
  buffer_load_dwordx4 v225, s[44:47], s23 offen offset:1024 nt lds
  buffer_load_dwordx4 v226, s[44:47], s23 offen offset:2048 nt lds
  buffer_load_dwordx4 v227, s[44:47], s23 offen offset:3072 nt lds
  s_lshl_b32 s68, s87, 2
  s_add_u32 s68, s68, s3
  s_lshl_b32 s10, s76, 5
  s_add_u32 s68, s68, s10
  s_add_u32 s68, s68, 96
  s_lshr_b32 s22, s68, 6
  s_add_u32 s22, s22, s64
  s_and_b32 s22, s22, 7
  s_lshl_b32 s22, s22, 8
  s_and_b32 s23, s68, 63
  s_add_u32 s22, s22, s23
  s_lshl_b32 s22, s22, 13
  s_add_u32 s22, s22, s9
  s_add_u32 s23, s22, 4096
  s_mov_b32 s44, s18
  s_mov_b32 s45, s19
  s_waitcnt vmcnt(4)
  s_add_u32 m0, s77, 16384
  s_nop 0
  buffer_load_dwordx4 v224, s[44:47], s22 offen offset:0 nt lds
  buffer_load_dwordx4 v225, s[44:47], s22 offen offset:1024 nt lds
  buffer_load_dwordx4 v226, s[44:47], s22 offen offset:2048 nt lds
  buffer_load_dwordx4 v227, s[44:47], s22 offen offset:3072 nt lds
  s_add_u32 m0, s77, 20480
  s_nop 0
  buffer_load_dwordx4 v224, s[44:47], s23 offen offset:0 nt lds
  buffer_load_dwordx4 v225, s[44:47], s23 offen offset:1024 nt lds
  buffer_load_dwordx4 v226, s[44:47], s23 offen offset:2048 nt lds
  buffer_load_dwordx4 v227, s[44:47], s23 offen offset:3072 nt lds
  s_waitcnt vmcnt(4)
  buffer_load_dwordx4 v[128:131], v4, s[48:51], s16 offen offset:0 nt
  buffer_load_dwordx4 v[132:135], v4, s[48:51], s16 offen offset:1024 nt
  buffer_load_dwordx4 v[136:139], v4, s[48:51], s16 offen offset:2048 nt
  buffer_load_dwordx4 v[140:143], v4, s[48:51], s16 offen offset:3072 nt
  buffer_load_dwordx4 v[144:147], v5, s[48:51], s16 offen offset:0 nt
  buffer_load_dwordx4 v[148:151], v5, s[48:51], s16 offen offset:1024 nt
  buffer_load_dwordx4 v[152:155], v5, s[48:51], s16 offen offset:2048 nt
  buffer_load_dwordx4 v[156:159], v5, s[48:51], s16 offen offset:3072 nt
  s_waitcnt vmcnt(4)
  buffer_load_dwordx4 v[160:163], v4, s[48:51], s17 offen offset:0 nt
  buffer_load_dwordx4 v[164:167], v4, s[48:51], s17 offen offset:1024 nt
  buffer_load_dwordx4 v[168:171], v4, s[48:51], s17 offen offset:2048 nt
  buffer_load_dwordx4 v[172:175], v4, s[48:51], s17 offen offset:3072 nt
  buffer_load_dwordx4 v[176:179], v5, s[48:51], s17 offen offset:0 nt
  buffer_load_dwordx4 v[180:183], v5, s[48:51], s17 offen offset:1024 nt
  buffer_load_dwordx4 v[184:187], v5, s[48:51], s17 offen offset:2048 nt
  buffer_load_dwordx4 v[188:191], v5, s[48:51], s17 offen offset:3072 nt
  s_mov_b32 s48, s20
  s_mov_b32 s49, s21
  s_waitcnt vmcnt(4)
  buffer_load_dwordx4 v[192:195], v4, s[48:51], s22 offen offset:0 nt
  buffer_load_dwordx4 v[196:199], v4, s[48:51], s22 offen offset:1024 nt
  buffer_load_dwordx4 v[200:203], v4, s[48:51], s22 offen offset:2048 nt
  buffer_load_dwordx4 v[204:207], v4, s[48:51], s22 offen offset:3072 nt
  buffer_load_dwordx4 v[208:211], v5, s[48:51], s22 offen offset:0 nt
  buffer_load_dwordx4 v[212:215], v5, s[48:51], s22 offen offset:1024 nt
  buffer_load_dwordx4 v[216:219], v5, s[48:51], s22 offen offset:2048 nt
  buffer_load_dwordx4 v[220:223], v5, s[48:51], s22 offen offset:3072 nt
  s_mov_b32 s66, s68
  s_add_u32 s68, s68, 64
  s_lshr_b32 s22, s68, 6
  s_add_u32 s22, s22, s64
  s_and_b32 s22, s22, 7
  s_lshl_b32 s22, s22, 8
  s_and_b32 s23, s68, 63
  s_add_u32 s22, s22, s23
  s_lshl_b32 s22, s22, 13
  s_add_u32 s22, s22, s9
  s_add_u32 s23, s22, 4096
  s_barrier
L_S_INIT:
  v_add_u32 v15, s74, v12
  ds_read_b128 v[16:19], v15 offset:0
  ds_read_b128 v[20:23], v15 offset:64
  ds_read_b128 v[24:27], v15 offset:128
  ds_read_b128 v[28:31], v15 offset:192
  v_mov_b32 v10, 0xff7fffff
  v_mov_b32 v11, 0
  v_mov_b32 v32, 0
  v_mov_b32 v33, 0
  v_mov_b32 v34, 0
  v_mov_b32 v35, 0
  v_mov_b32 v36, 0
  v_mov_b32 v37, 0
  v_mov_b32 v38, 0
  v_mov_b32 v39, 0
  v_mov_b32 v40, 0
  v_mov_b32 v41, 0
  v_mov_b32 v42, 0
  v_mov_b32 v43, 0
  v_mov_b32 v44, 0
  v_mov_b32 v45, 0
  v_mov_b32 v46, 0
  v_mov_b32 v47, 0
  v_mov_b32 v48, 0
  v_mov_b32 v49, 0
  v_mov_b32 v50, 0
  v_mov_b32 v51, 0
  v_mov_b32 v52, 0
  v_mov_b32 v53, 0
  v_mov_b32 v54, 0
  v_mov_b32 v55, 0
  v_mov_b32 v56, 0
  v_mov_b32 v57, 0
  v_mov_b32 v58, 0
  v_mov_b32 v59, 0
  v_mov_b32 v60, 0
  v_mov_b32 v61, 0
  v_mov_b32 v62, 0
  v_mov_b32 v63, 0
  s_waitcnt lgkmcnt(0)
  s_cmp_eq_u32 s78, 1
  s_cbranch_scc1 L_S_PRO2
  s_waitcnt vmcnt(40)
  s_mov_b32 s24, 0
  s_call_b64 s[82:83], L_QK
  s_add_u32 m0, s77, 0
  s_nop 0
  buffer_load_dwordx4 v224, s[44:47], s22 offen offset:0 nt lds
  buffer_load_dwordx4 v225, s[44:47], s22 offen offset:1024 nt lds
  buffer_load_dwordx4 v226, s[44:47], s22 offen offset:2048 nt lds
  buffer_load_dwordx4 v227, s[44:47], s22 offen offset:3072 nt lds
  s_add_u32 m0, s77, 4096
  s_nop 0
  buffer_load_dwordx4 v224, s[44:47], s23 offen offset:0 nt lds
  buffer_load_dwordx4 v225, s[44:47], s23 offen offset:1024 nt lds
  buffer_load_dwordx4 v226, s[44:47], s23 offen offset:2048 nt lds
  buffer_load_dwordx4 v227, s[44:47], s23 offen offset:3072 nt lds
  s_mov_b32 s16, s22
  s_waitcnt vmcnt(24)
  s_call_b64 s[82:83], L_PV0
  s_mov_b32 s24, 8192
  s_call_b64 s[82:83], L_QK
  s_add_u32 s68, s68, 64
  s_lshr_b32 s22, s68, 6
  s_add_u32 s22, s22, s64
  s_and_b32 s22, s22, 7
  s_lshl_b32 s22, s22, 8
  s_and_b32 s23, s68, 63
  s_add_u32 s22, s22, s23
  s_lshl_b32 s22, s22, 13
  s_add_u32 s22, s22, s9
  s_add_u32 s23, s22, 4096
  s_add_u32 m0, s77, 8192
  s_nop 0
  buffer_load_dwordx4 v224, s[44:47], s22 offen offset:0 nt lds
  buffer_load_dwordx4 v225, s[44:47], s22 offen offset:1024 nt lds
  buffer_load_dwordx4 v226, s[44:47], s22 offen offset:2048 nt lds
  buffer_load_dwordx4 v227, s[44:47], s22 offen offset:3072 nt lds
  s_add_u32 m0, s77, 12288
  s_nop 0
  buffer_load_dwordx4 v224, s[44:47], s23 offen offset:0 nt lds
  buffer_load_dwordx4 v225, s[44:47], s23 offen offset:1024 nt lds
  buffer_load_dwordx4 v226, s[44:47], s23 offen offset:2048 nt lds
  buffer_load_dwordx4 v227, s[44:47], s23 offen offset:3072 nt lds
  s_mov_b32 s17, s22
  s_waitcnt vmcnt(24)
  s_call_b64 s[82:83], L_PV1
  s_cmp_eq_u32 s67, 1
  s_cbranch_scc1 L_S_FLUSH
L_S_PRO2:
  s_mov_b32 s24, 16384
  s_call_b64 s[82:83], L_QK
  s_add_u32 s68, s68, 64
  s_lshr_b32 s22, s68, 6
  s_add_u32 s22, s22, s64
  s_and_b32 s22, s22, 7
  s_lshl_b32 s22, s22, 8
  s_and_b32 s23, s68, 63
  s_add_u32 s22, s22, s23
  s_lshl_b32 s22, s22, 13
  s_add_u32 s22, s22, s9
  s_add_u32 s23, s22, 4096
  s_add_u32 m0, s77, 16384
  s_nop 0
  buffer_load_dwordx4 v224, s[44:47], s22 offen offset:0 nt lds
  buffer_load_dwordx4 v225, s[44:47], s22 offen offset:1024 nt lds
  buffer_load_dwordx4 v226, s[44:47], s22 offen offset:2048 nt lds
  buffer_load_dwordx4 v227, s[44:47], s22 offen offset:3072 nt lds
  s_add_u32 m0, s77, 20480
  s_nop 0
  buffer_load_dwordx4 v224, s[44:47], s23 offen offset:0 nt lds
  buffer_load_dwordx4 v225, s[44:47], s23 offen offset:1024 nt lds
  buffer_load_dwordx4 v226, s[44:47], s23 offen offset:2048 nt lds
  buffer_load_dwordx4 v227, s[44:47], s23 offen offset:3072 nt lds
  s_waitcnt vmcnt(24)
  s_call_b64 s[82:83], L_PV2
  s_waitcnt vmcnt(4)
  buffer_load_dwordx4 v[128:131], v4, s[48:51], s16 offen offset:0 nt
  buffer_load_dwordx4 v[132:135], v4, s[48:51], s16 offen offset:1024 nt
  buffer_load_dwordx4 v[136:139], v4, s[48:51], s16 offen offset:2048 nt
  buffer_load_dwordx4 v[140:143], v4, s[48:51], s16 offen offset:3072 nt
  buffer_load_dwordx4 v[144:147], v5, s[48:51], s16 offen offset:0 nt
  buffer_load_dwordx4 v[148:151], v5, s[48:51], s16 offen offset:1024 nt
  buffer_load_dwordx4 v[152:155], v5, s[48:51], s16 offen offset:2048 nt
  buffer_load_dwordx4 v[156:159], v5, s[48:51], s16 offen offset:3072 nt
  s_mov_b32 s24, 0
  s_call_b64 s[82:83], L_QK
  s_waitcnt vmcnt(4)
  buffer_load_dwordx4 v[160:163], v4, s[48:51], s17 offen offset:0 nt
  buffer_load_dwordx4 v[164:167], v4, s[48:51], s17 offen offset:1024 nt
  buffer_load_dwordx4 v[168:171], v4, s[48:51], s17 offen offset:2048 nt
  buffer_load_dwordx4 v[172:175], v4, s[48:51], s17 offen offset:3072 nt
  buffer_load_dwordx4 v[176:179], v5, s[48:51], s17 offen offset:0 nt
  buffer_load_dwordx4 v[180:183], v5, s[48:51], s17 offen offset:1024 nt
  buffer_load_dwordx4 v[184:187], v5, s[48:51], s17 offen offset:2048 nt
  buffer_load_dwordx4 v[188:191], v5, s[48:51], s17 offen offset:3072 nt
  s_waitcnt vmcnt(4)
  buffer_load_dwordx4 v[192:195], v4, s[48:51], s22 offen offset:0 nt
  buffer_load_dwordx4 v[196:199], v4, s[48:51], s22 offen offset:1024 nt
  buffer_load_dwordx4 v[200:203], v4, s[48:51], s22 offen offset:2048 nt
  buffer_load_dwordx4 v[204:207], v4, s[48:51], s22 offen offset:3072 nt
  buffer_load_dwordx4 v[208:211], v5, s[48:51], s22 offen offset:0 nt
  buffer_load_dwordx4 v[212:215], v5, s[48:51], s22 offen offset:1024 nt
  buffer_load_dwordx4 v[216:219], v5, s[48:51], s22 offen offset:2048 nt
  buffer_load_dwordx4 v[220:223], v5, s[48:51], s22 offen offset:3072 nt
  s_waitcnt vmcnt(20)
  s_mov_b32 s68, 1
  s_atomic_add s68, s[40:41], s69 glc
  s_waitcnt vmcnt(16)
  s_call_b64 s[82:83], L_PV0
  s_waitcnt lgkmcnt(0)
  s_cmp_ge_u32 s68, 512
  s_cbranch_scc1 L_S_BX
  s_lshr_b32 s22, s68, 6
  s_add_u32 s22, s22, s64
  s_and_b32 s22, s22, 7
  s_lshl_b32 s22, s22, 8
  s_and_b32 s23, s68, 63
  s_add_u32 s22, s22, s23
  s_lshl_b32 s22, s22, 13
  s_add_u32 s22, s22, s9
  s_add_u32 s23, s22, 4096
  s_waitcnt vmcnt(4)
  s_add_u32 m0, s77, 0
  s_nop 0
  buffer_load_dwordx4 v224, s[44:47], s22 offen offset:0 nt lds
  buffer_load_dwordx4 v225, s[44:47], s22 offen offset:1024 nt lds
  buffer_load_dwordx4 v226, s[44:47], s22 offen offset:2048 nt lds
  buffer_load_dwordx4 v227, s[44:47], s22 offen offset:3072 nt lds
  s_add_u32 m0, s77, 4096
  s_nop 0
  buffer_load_dwordx4 v224, s[44:47], s23 offen offset:0 nt lds
  buffer_load_dwordx4 v225, s[44:47], s23 offen offset:1024 nt lds
  buffer_load_dwordx4 v226, s[44:47], s23 offen offset:2048 nt lds
  buffer_load_dwordx4 v227, s[44:47], s23 offen offset:3072 nt lds
  buffer_load_dwordx4 v[128:131], v4, s[48:51], s22 offen offset:0 nt
  buffer_load_dwordx4 v[132:135], v4, s[48:51], s22 offen offset:1024 nt
  buffer_load_dwordx4 v[136:139], v4, s[48:51], s22 offen offset:2048 nt
  buffer_load_dwordx4 v[140:143], v4, s[48:51], s22 offen offset:3072 nt
  buffer_load_dwordx4 v[144:147], v5, s[48:51], s22 offen offset:0 nt
  buffer_load_dwordx4 v[148:151], v5, s[48:51], s22 offen offset:1024 nt
  buffer_load_dwordx4 v[152:155], v5, s[48:51], s22 offen offset:2048 nt
  buffer_load_dwordx4 v[156:159], v5, s[48:51], s22 offen offset:3072 nt
  s_mov_b32 s24, 8192
  s_call_b64 s[82:83], L_QK
  s_waitcnt vmcnt(24)
  s_call_b64 s[82:83], L_PV1
  s_mov_b32 s24, 16384
  s_call_b64 s[82:83], L_QK
  s_waitcnt vmcnt(16)
  s_call_b64 s[82:83], L_PV2
L_S_L0:
  s_waitcnt vmcnt(8)
  ds_read_b32 v15, v92 offset:12
  s_waitcnt lgkmcnt(0)
  v_readfirstlane_b32 s10, v15
  s_nop 0
  s_cmp_lg_u32 s10, 0
  s_cbranch_scc1 L_S_Q0
L_S_G0:
  s_mov_b32 s68, 1
  s_atomic_add s68, s[40:41], s69 glc
  s_waitcnt vmcnt(4)
  s_waitcnt lgkmcnt(0)
  s_cmp_ge_u32 s68, 512
  s_cbranch_scc1 L_S_E0
  s_lshr_b32 s22, s68, 6
  s_add_u32 s22, s22, s64
  s_and_b32 s22, s22, 7
  s_lshl_b32 s22, s22, 8
  s_and_b32 s23, s68, 63
  s_add_u32 s22, s22, s23
  s_lshl_b32 s22, s22, 13
  s_add_u32 s22, s22, s9
  s_add_u32 s23, s22, 4096
  s_add_u32 m0, s77, 8192
  s_nop 0
  buffer_load_dwordx4 v224, s[44:47], s22 offen offset:0 nt lds
  buffer_load_dwordx4 v225, s[44:47], s22 offen offset:1024 nt lds
  buffer_load_dwordx4 v226, s[44:47], s22 offen offset:2048 nt lds
  buffer_load_dwordx4 v227, s[44:47], s22 offen offset:3072 nt lds
  s_add_u32 m0, s77, 12288
  s_nop 0
  buffer_load_dwordx4 v224, s[44:47], s23 offen offset:0 nt lds
  buffer_load_dwordx4 v225, s[44:47], s23 offen offset:1024 nt lds
  buffer_load_dwordx4 v226, s[44:47], s23 offen offset:2048 nt lds
  buffer_load_dwordx4 v227, s[44:47], s23 offen offset:3072 nt lds
  buffer_load_dwordx4 v[160:163], v4, s[48:51], s22 offen offset:0 nt
  buffer_load_dwordx4 v[164:167], v4, s[48:51], s22 offen offset:1024 nt
  buffer_load_dwordx4 v[168:171], v4, s[48:51], s22 offen offset:2048 nt
  buffer_load_dwordx4 v[172:175], v4, s[48:51], s22 offen offset:3072 nt
  buffer_load_dwordx4 v[176:179], v5, s[48:51], s22 offen offset:0 nt
  buffer_load_dwordx4 v[180:183], v5, s[48:51], s22 offen offset:1024 nt
  buffer_load_dwordx4 v[184:187], v5, s[48:51], s22 offen offset:2048 nt
  buffer_load_dwordx4 v[188:191], v5, s[48:51], s22 offen offset:3072 nt
  s_mov_b32 s24, 0
  s_call_b64 s[82:83], L_QK
  s_waitcnt vmcnt(16)
  s_call_b64 s[82:83], L_PV0
L_S_L1:
  s_waitcnt vmcnt(8)
  ds_read_b32 v15, v92 offset:12
  s_waitcnt lgkmcnt(0)
  v_readfirstlane_b32 s10, v15
  s_nop 0
  s_cmp_lg_u32 s10, 0
  s_cbranch_scc1 L_S_Q1
L_S_G1:
  s_mov_b32 s68, 1
  s_atomic_add s68, s[40:41], s69 glc
  s_waitcnt vmcnt(4)
  s_waitcnt lgkmcnt(0)
  s_cmp_ge_u32 s68, 512
  s_cbranch_scc1 L_S_E1
  s_lshr_b32 s22, s68, 6
  s_add_u32 s22, s22, s64
  s_and_b32 s22, s22, 7
  s_lshl_b32 s22, s22, 8
  s_and_b32 s23, s68, 63
  s_add_u32 s22, s22, s23
  s_lshl_b32 s22, s22, 13
  s_add_u32 s22, s22, s9
  s_add_u32 s23, s22, 4096
  s_add_u32 m0, s77, 0
  s_nop 0
  buffer_load_dwordx4 v224, s[44:47], s22 offen offset:0 nt lds
  buffer_load_dwordx4 v225, s[44:47], s22 offen offset:1024 nt lds
  buffer_load_dwordx4 v226, s[44:47], s22 offen offset:2048 nt lds
  buffer_load_dwordx4 v227, s[44:47], s22 offen offset:3072 nt lds
  s_add_u32 m0, s77, 4096
  s_nop 0
  buffer_load_dwordx4 v224, s[44:47], s23 offen offset:0 nt lds
  buffer_load_dwordx4 v225, s[44:47], s23 offen offset:1024 nt lds
  buffer_load_dwordx4 v226, s[44:47], s23 offen offset:2048 nt lds
  buffer_load_dwordx4 v227, s[44:47], s23 offen offset:3072 nt lds
  buffer_load_dwordx4 v[128:131], v4, s[48:51], s22 offen offset:0 nt
  buffer_load_dwordx4 v[132:135], v4, s[48:51], s22 offen offset:1024 nt
  buffer_load_dwordx4 v[136:139], v4, s[48:51], s22 offen offset:2048 nt
  buffer_load_dwordx4 v[140:143], v4, s[48:51], s22 offen offset:3072 nt
  buffer_load_dwordx4 v[144:147], v5, s[48:51], s22 offen offset:0 nt
  buffer_load_dwordx4 v[148:151], v5, s[48:51], s22 offen offset:1024 nt
  buffer_load_dwordx4 v[152:155], v5, s[48:51], s22 offen offset:2048 nt
  buffer_load_dwordx4 v[156:159], v5, s[48:51], s22 offen offset:3072 nt
  s_mov_b32 s24, 8192
  s_call_b64 s[82:83], L_QK
  s_waitcnt vmcnt(16)
  s_call_b64 s[82:83], L_PV1
  s_branch L_S_L0
L_S_BX:
  ds_write_b32 v92, v93 offset:12
  s_mov_b64 exec, 1
  ds_add_u32 v92, v94 offset:24
  s_mov_b64 exec, -1
  s_mov_b32 s24, 8192
  s_call_b64 s[82:83], L_QK
  s_waitcnt vmcnt(8)
  s_call_b64 s[82:83], L_PV1
  s_mov_b32 s24, 16384
  s_call_b64 s[82:83], L_QK
  s_waitcnt vmcnt(0)
  s_call_b64 s[82:83], L_PV2
  s_branch L_S_FLUSH
L_S_E0:
  ds_write_b32 v92, v93 offset:12
L_S_Q0:
  s_mov_b64 exec, 1
  ds_add_u32 v92, v94 offset:24
  s_mov_b64 exec, -1
  s_waitcnt vmcnt(8)
  s_mov_b32 s24, 0
  s_call_b64 s[82:83], L_QK
  s_waitcnt vmcnt(0)
  s_call_b64 s[82:83], L_PV0
  s_branch L_S_FLUSH
L_S_E1:
  ds_write_b32 v92, v93 offset:12
L_S_Q1:
  s_mov_b64 exec, 1
  ds_add_u32 v92, v94 offset:24
  s_mov_b64 exec, -1
  s_waitcnt vmcnt(8)
  s_mov_b32 s24, 8192
  s_call_b64 s[82:83], L_QK
  s_waitcnt vmcnt(0)
  s_call_b64 s[82:83], L_PV1
L_S_FLUSH:
  v_mov_b32 v9, v11
  s_mul_i32 s25, s72, 4224
  v_add_u32 v8, s25, v13
  v_permlane16_swap_b32 v11, v9
  v_add_f32 v11, v11, v9
  v_mov_b32 v9, v11
  s_lshl_b32 s25, s72, 6
  v_add_u32 v7, s25, v14
  v_permlane32_swap_b32 v11, v9
  v_add_f32 v11, v11, v9
  v_mov_b32 v15, s73
  s_mov_b32 s10, 0x00ff00ff
  s_mov_b32 s11, 0x00ff00ff
  s_mov_b64 exec, s[10:11]
  ds_write_b64 v7, v[10:11] offset:12544
  ds_write_b128 v8, v[32:35] offset:21248
  ds_write_b128 v8, v[36:39] offset:21264
  ds_write_b128 v8, v[40:43] offset:21280
  ds_write_b128 v8, v[44:47] offset:21296
  ds_write_b128 v8, v[48:51] offset:21312
  ds_write_b128 v8, v[52:55] offset:21328
  ds_write_b128 v8, v[56:59] offset:21344
  ds_write_b128 v8, v[60:63] offset:21360
  s_mov_b64 exec, 1
  ds_add_u32 v15, v93 offset:0
  s_mov_b64 exec, -1
  s_cmp_eq_u32 s67, 0
  s_cbranch_scc1 L_S_DONE
  s_mov_b32 s67, 0
  s_mov_b32 s78, 1
  s_mov_b32 s72, s3
  s_mov_b32 s73, 0
  s_mov_b32 s74, 8448
  s_waitcnt lgkmcnt(0)
  s_branch L_S_INIT
L_S_DONE:
  s_call_b64 s[82:83], L_PRODUCE
  s_mov_b64 exec, 1
  ds_add_u32 v92, v93 offset:0
  s_mov_b64 exec, -1
  s_call_b64 s[82:83], L_WOLD
L_S_BS2:
  s_mov_b32 s15, 0
L_S_W7:
  ds_read_b32 v30, v92 offset:8
  s_add_u32 s15, s15, 1
  s_waitcnt lgkmcnt(0)
  v_readfirstlane_b32 s10, v30
  s_nop 0
  s_cmp_ge_u32 s10, 4
  s_cbranch_scc1 L_S_W7_D
  s_sleep 2
  s_cmp_lt_u32 s15, 1600000
  s_cbranch_scc1 L_S_W7
L_S_W7_D:
  s_waitcnt vmcnt(0)
  v_mov_b32 v8, s91
  v_add_u32 v9, 2869, v8
  v_add_u32 v10, 9617, v8
  v_add_u32 v11, 1383, v8
  s_call_b64 s[82:83], L_WPERM
  s_call_b64 s[82:83], L_OUT
L_END:
  s_endpgm
L_QK:
  v_add_u32 v232, s24, v228
  v_add_u32 v233, s24, v229
  v_add_u32 v234, s24, v230
  v_add_u32 v235, s24, v231
  ds_read_b128 v[96:99], v232 offset:0
  ds_read_b128 v[112:115], v232 offset:4096
  ds_read_b128 v[100:103], v233 offset:0
  ds_read_b128 v[116:119], v233 offset:4096
  ds_read_b128 v[104:107], v234 offset:0
  ds_read_b128 v[120:123], v234 offset:4096
  ds_read_b128 v[108:111], v235 offset:0
  ds_read_b128 v[124:127], v235 offset:4096
  s_waitcnt lgkmcnt(7)
  v_mfma_f32_16x16x32_bf16 v[64:67], v[96:99], v[16:19], 0
  s_waitcnt lgkmcnt(6)
  v_mfma_f32_16x16x32_bf16 v[68:71], v[112:115], v[16:19], 0
  s_waitcnt lgkmcnt(5)
  v_mfma_f32_16x16x32_bf16 v[64:67], v[100:103], v[20:23], v[64:67]
  s_waitcnt lgkmcnt(4)
  v_mfma_f32_16x16x32_bf16 v[68:71], v[116:119], v[20:23], v[68:71]
  s_waitcnt lgkmcnt(3)
  v_mfma_f32_16x16x32_bf16 v[64:67], v[104:107], v[24:27], v[64:67]
  s_waitcnt lgkmcnt(2)
  v_mfma_f32_16x16x32_bf16 v[68:71], v[120:123], v[24:27], v[68:71]
  s_waitcnt lgkmcnt(1)
  v_mfma_f32_16x16x32_bf16 v[64:67], v[108:111], v[28:31], v[64:67]
  s_waitcnt lgkmcnt(0)
  v_mfma_f32_16x16x32_bf16 v[68:71], v[124:127], v[28:31], v[68:71]
  s_mov_b64 exec, 1
  ds_add_u32 v92, v93 offset:24
  s_mov_b64 exec, -1
  s_nop 2
  v_cvt_pk_bf16_f32 v72, v64, v65
  v_cvt_pk_bf16_f32 v73, v66, v67
  v_cvt_pk_bf16_f32 v74, v68, v69
  v_cvt_pk_bf16_f32 v75, v70, v71
  v_lshlrev_b32 v64, 16, v72
  v_and_b32 v65, s14, v72
  v_lshlrev_b32 v66, 16, v73
  v_and_b32 v67, s14, v73
  v_lshlrev_b32 v68, 16, v74
  v_and_b32 v69, s14, v74
  v_lshlrev_b32 v70, 16, v75
  v_and_b32 v71, s14, v75
  v_pk_mul_f32 v[64:65], v[64:65], s[62:63]
  v_pk_mul_f32 v[66:67], v[66:67], s[62:63]
  v_pk_mul_f32 v[68:69], v[68:69], s[62:63]
  v_pk_mul_f32 v[70:71], v[70:71], s[62:63]
  v_cvt_pk_bf16_f32 v72, v64, v65
  v_cvt_pk_bf16_f32 v73, v66, v67
  v_cvt_pk_bf16_f32 v74, v68, v69
  v_cvt_pk_bf16_f32 v75, v70, v71
  v_lshlrev_b32 v64, 16, v72
  v_and_b32 v65, s14, v72
  v_lshlrev_b32 v66, 16, v73
  v_and_b32 v67, s14, v73
  v_lshlrev_b32 v68, 16, v74
  v_and_b32 v69, s14, v74
  v_lshlrev_b32 v70, 16, v75
  v_and_b32 v71, s14, v75
  v_max3_f32 v8, v64, v65, v66
  v_max3_f32 v9, v67, v68, v69
  v_max3_f32 v8, v8, v70, v71
  v_max_f32 v8, v8, v9
  v_mov_b32 v9, v8
  s_nop 1
  v_permlane16_swap_b32 v8, v9
  v_max_f32 v8, v8, v9
  v_mov_b32 v9, v8
  s_nop 1
  v_permlane32_swap_b32 v8, v9
  v_max_f32 v8, v8, v9
  v_mul_f32 v8, s60, v8
  v_max_f32 v8, v8, v10
  v_sub_f32 v9, v10, v8
  v_pk_fma_f32 v[64:65], v[64:65], s[60:61], v[8:9] op_sel_hi:[1,1,0] neg_lo:[0,0,1] neg_hi:[0,0,1]
  v_pk_fma_f32 v[66:67], v[66:67], s[60:61], v[8:9] op_sel_hi:[1,1,0] neg_lo:[0,0,1] neg_hi:[0,0,1]
  v_pk_fma_f32 v[68:69], v[68:69], s[60:61], v[8:9] op_sel_hi:[1,1,0] neg_lo:[0,0,1] neg_hi:[0,0,1]
  v_pk_fma_f32 v[70:71], v[70:71], s[60:61], v[8:9] op_sel_hi:[1,1,0] neg_lo:[0,0,1] neg_hi:[0,0,1]
  v_exp_f32 v9, v9
  v_exp_f32 v64, v64
  v_exp_f32 v65, v65
  v_exp_f32 v66, v66
  v_exp_f32 v67, v67
  v_exp_f32 v68, v68
  v_exp_f32 v69, v69
  v_exp_f32 v70, v70
  v_exp_f32 v71, v71
  v_cmp_neq_f32 vcc, 1.0, v9
  v_mov_b32 v10, v8
  v_cvt_pk_bf16_f32 v72, v64, v65
  v_cvt_pk_bf16_f32 v73, v66, v67
  v_cvt_pk_bf16_f32 v74, v68, v69
  v_cvt_pk_bf16_f32 v75, v70, v71
  v_pk_add_f32 v[64:65], v[64:65], v[66:67]
  v_pk_add_f32 v[68:69], v[68:69], v[70:71]
  v_pk_add_f32 v[64:65], v[64:65], v[68:69]
  v_fma_f32 v11, v11, v9, v64
  v_add_f32 v11, v11, v65
  s_cbranch_vccz L_QK_R
  v_pk_mul_f32 v[32:33], v[32:33], v[8:9] op_sel:[0,1] op_sel_hi:[1,1]
  v_pk_mul_f32 v[34:35], v[34:35], v[8:9] op_sel:[0,1] op_sel_hi:[1,1]
  v_pk_mul_f32 v[36:37], v[36:37], v[8:9] op_sel:[0,1] op_sel_hi:[1,1]
  v_pk_mul_f32 v[38:39], v[38:39], v[8:9] op_sel:[0,1] op_sel_hi:[1,1]
  v_pk_mul_f32 v[40:41], v[40:41], v[8:9] op_sel:[0,1] op_sel_hi:[1,1]
  v_pk_mul_f32 v[42:43], v[42:43], v[8:9] op_sel:[0,1] op_sel_hi:[1,1]
  v_pk_mul_f32 v[44:45], v[44:45], v[8:9] op_sel:[0,1] op_sel_hi:[1,1]
  v_pk_mul_f32 v[46:47], v[46:47], v[8:9] op_sel:[0,1] op_sel_hi:[1,1]
  v_pk_mul_f32 v[48:49], v[48:49], v[8:9] op_sel:[0,1] op_sel_hi:[1,1]
  v_pk_mul_f32 v[50:51], v[50:51], v[8:9] op_sel:[0,1] op_sel_hi:[1,1]
  v_pk_mul_f32 v[52:53], v[52:53], v[8:9] op_sel:[0,1] op_sel_hi:[1,1]
  v_pk_mul_f32 v[54:55], v[54:55], v[8:9] op_sel:[0,1] op_sel_hi:[1,1]
  v_pk_mul_f32 v[56:57], v[56:57], v[8:9] op_sel:[0,1] op_sel_hi:[1,1]
  v_pk_mul_f32 v[58:59], v[58:59], v[8:9] op_sel:[0,1] op_sel_hi:[1,1]
  v_pk_mul_f32 v[60:61], v[60:61], v[8:9] op_sel:[0,1] op_sel_hi:[1,1]
  v_pk_mul_f32 v[62:63], v[62:63], v[8:9] op_sel:[0,1] op_sel_hi:[1,1]
L_QK_R:
  s_setpc_b64 s[82:83]
L_PV0:
  v_perm_b32 v76, v132, v128, s4
  v_perm_b32 v77, v140, v136, s4
  v_perm_b32 v78, v148, v144, s4
  v_perm_b32 v79, v156, v152, s4
  v_perm_b32 v80, v132, v128, s5
  v_perm_b32 v81, v140, v136, s5
  v_perm_b32 v82, v148, v144, s5
  v_perm_b32 v83, v156, v152, s5
  v_perm_b32 v84, v133, v129, s4
  v_perm_b32 v85, v141, v137, s4
  v_perm_b32 v86, v149, v145, s4
  v_perm_b32 v87, v157, v153, s4
  v_perm_b32 v88, v133, v129, s5
  v_perm_b32 v89, v141, v137, s5
  v_perm_b32 v90, v149, v145, s5
  v_perm_b32 v91, v157, v153, s5
  v_mfma_f32_16x16x32_bf16 v[32:35], v[76:79], v[72:75], v[32:35]
  v_mfma_f32_16x16x32_bf16 v[36:39], v[80:83], v[72:75], v[36:39]
  v_perm_b32 v76, v134, v130, s4
  v_perm_b32 v77, v142, v138, s4
  v_perm_b32 v78, v150, v146, s4
  v_perm_b32 v79, v158, v154, s4
  v_perm_b32 v80, v134, v130, s5
  v_perm_b32 v81, v142, v138, s5
  v_perm_b32 v82, v150, v146, s5
  v_perm_b32 v83, v158, v154, s5
  v_mfma_f32_16x16x32_bf16 v[40:43], v[84:87], v[72:75], v[40:43]
  v_mfma_f32_16x16x32_bf16 v[44:47], v[88:91], v[72:75], v[44:47]
  v_perm_b32 v84, v135, v131, s4
  v_perm_b32 v85, v143, v139, s4
  v_perm_b32 v86, v151, v147, s4
  v_perm_b32 v87, v159, v155, s4
  v_perm_b32 v88, v135, v131, s5
  v_perm_b32 v89, v143, v139, s5
  v_perm_b32 v90, v151, v147, s5
  v_perm_b32 v91, v159, v155, s5
  v_mfma_f32_16x16x32_bf16 v[48:51], v[76:79], v[72:75], v[48:51]
  v_mfma_f32_16x16x32_bf16 v[52:55], v[80:83], v[72:75], v[52:55]
  v_mfma_f32_16x16x32_bf16 v[56:59], v[84:87], v[72:75], v[56:59]
  v_mfma_f32_16x16x32_bf16 v[60:63], v[88:91], v[72:75], v[60:63]
  s_setpc_b64 s[82:83]
L_PV1:
  v_perm_b32 v76, v164, v160, s4
  v_perm_b32 v77, v172, v168, s4
  v_perm_b32 v78, v180, v176, s4
  v_perm_b32 v79, v188, v184, s4
  v_perm_b32 v80, v164, v160, s5
  v_perm_b32 v81, v172, v168, s5
  v_perm_b32 v82, v180, v176, s5
  v_perm_b32 v83, v188, v184, s5
  v_perm_b32 v84, v165, v161, s4
  v_perm_b32 v85, v173, v169, s4
  v_perm_b32 v86, v181, v177, s4
  v_perm_b32 v87, v189, v185, s4
  v_perm_b32 v88, v165, v161, s5
  v_perm_b32 v89, v173, v169, s5
  v_perm_b32 v90, v181, v177, s5
  v_perm_b32 v91, v189, v185, s5
  v_mfma_f32_16x16x32_bf16 v[32:35], v[76:79], v[72:75], v[32:35]
  v_mfma_f32_16x16x32_bf16 v[36:39], v[80:83], v[72:75], v[36:39]
  v_perm_b32 v76, v166, v162, s4
  v_perm_b32 v77, v174, v170, s4
  v_perm_b32 v78, v182, v178, s4
  v_perm_b32 v79, v190, v186, s4
  v_perm_b32 v80, v166, v162, s5
  v_perm_b32 v81, v174, v170, s5
  v_perm_b32 v82, v182, v178, s5
  v_perm_b32 v83, v190, v186, s5
  v_mfma_f32_16x16x32_bf16 v[40:43], v[84:87], v[72:75], v[40:43]
  v_mfma_f32_16x16x32_bf16 v[44:47], v[88:91], v[72:75], v[44:47]
  v_perm_b32 v84, v167, v163, s4
  v_perm_b32 v85, v175, v171, s4
  v_perm_b32 v86, v183, v179, s4
  v_perm_b32 v87, v191, v187, s4
  v_perm_b32 v88, v167, v163, s5
  v_perm_b32 v89, v175, v171, s5
  v_perm_b32 v90, v183, v179, s5
  v_perm_b32 v91, v191, v187, s5
  v_mfma_f32_16x16x32_bf16 v[48:51], v[76:79], v[72:75], v[48:51]
  v_mfma_f32_16x16x32_bf16 v[52:55], v[80:83], v[72:75], v[52:55]
  v_mfma_f32_16x16x32_bf16 v[56:59], v[84:87], v[72:75], v[56:59]
  v_mfma_f32_16x16x32_bf16 v[60:63], v[88:91], v[72:75], v[60:63]
  s_setpc_b64 s[82:83]
L_PV2:
  v_perm_b32 v76, v196, v192, s4
  v_perm_b32 v77, v204, v200, s4
  v_perm_b32 v78, v212, v208, s4
  v_perm_b32 v79, v220, v216, s4
  v_perm_b32 v80, v196, v192, s5
  v_perm_b32 v81, v204, v200, s5
  v_perm_b32 v82, v212, v208, s5
  v_perm_b32 v83, v220, v216, s5
  v_perm_b32 v84, v197, v193, s4
  v_perm_b32 v85, v205, v201, s4
  v_perm_b32 v86, v213, v209, s4
  v_perm_b32 v87, v221, v217, s4
  v_perm_b32 v88, v197, v193, s5
  v_perm_b32 v89, v205, v201, s5
  v_perm_b32 v90, v213, v209, s5
  v_perm_b32 v91, v221, v217, s5
  v_mfma_f32_16x16x32_bf16 v[32:35], v[76:79], v[72:75], v[32:35]
  v_mfma_f32_16x16x32_bf16 v[36:39], v[80:83], v[72:75], v[36:39]
  v_perm_b32 v76, v198, v194, s4
  v_perm_b32 v77, v206, v202, s4
  v_perm_b32 v78, v214, v210, s4
  v_perm_b32 v79, v222, v218, s4
  v_perm_b32 v80, v198, v194, s5
  v_perm_b32 v81, v206, v202, s5
  v_perm_b32 v82, v214, v210, s5
  v_perm_b32 v83, v222, v218, s5
  v_mfma_f32_16x16x32_bf16 v[40:43], v[84:87], v[72:75], v[40:43]
  v_mfma_f32_16x16x32_bf16 v[44:47], v[88:91], v[72:75], v[44:47]
  v_perm_b32 v84, v199, v195, s4
  v_perm_b32 v85, v207, v203, s4
  v_perm_b32 v86, v215, v211, s4
  v_perm_b32 v87, v223, v219, s4
  v_perm_b32 v88, v199, v195, s5
  v_perm_b32 v89, v207, v203, s5
  v_perm_b32 v90, v215, v211, s5
  v_perm_b32 v91, v223, v219, s5
  v_mfma_f32_16x16x32_bf16 v[48:51], v[76:79], v[72:75], v[48:51]
  v_mfma_f32_16x16x32_bf16 v[52:55], v[80:83], v[72:75], v[52:55]
  v_mfma_f32_16x16x32_bf16 v[56:59], v[84:87], v[72:75], v[56:59]
  v_mfma_f32_16x16x32_bf16 v[60:63], v[88:91], v[72:75], v[60:63]
  s_setpc_b64 s[82:83]
L_CODE_END:
  s_endpgm
.section .rodata,"a"
.p2align 6
.amdhsa_kernel concat_heads__gqa_block_cached__sliding_block_cached__decode_kernel
  .amdhsa_next_free_vgpr 256
  .amdhsa_next_free_sgpr 102
  .amdhsa_accum_offset 256
  .amdhsa_group_segment_fixed_size 0
  .amdhsa_kernarg_size 104
  .amdhsa_user_sgpr_count 2
  .amdhsa_user_sgpr_kernarg_segment_ptr 1
  .amdhsa_system_sgpr_workgroup_id_x 1
.end_amdhsa_kernel
```
